```python
import torch

def _softmax(x, axis=-1):
    return torch.softmax(x, dim=axis)
def _gelu(x):
    return torch.nn.functional.gelu(x, approximate="tanh")
def _silu(x):
    return torch.nn.functional.silu(x)
def _sigmoid(x):
    return torch.sigmoid(x)
def _layernorm(x, axis=-1, eps=1e-5):
    m = x.mean(dim=axis, keepdim=True)
    v = x.var(dim=axis, keepdim=True, unbiased=False)
    return (x - m) / torch.sqrt(v + eps)
def _scatter_add(tgt, idx, src, axis=0):
    return tgt.clone().index_add_(axis, idx, src)
def _segment_sum(src, seg, n):
    out = torch.zeros((n,) + src.shape[1:], dtype=src.dtype)
    return out.index_add_(0, seg, src)
def _pad(x, pw):
    flat = tuple(v for pair in reversed(pw) for v in pair)
    return torch.nn.functional.pad(x, flat)

kernel_name = 'gated_mix__ssm_conv_s4d__glu_gated_swiglu__prompt'

def setup_inputs():

    _w = (lambda a: (lambda t: t.to(torch.bfloat16) if t.is_floating_point() else t)(torch.as_tensor(a)))
    def _A_setup():
        Bsz, L, D, N = 1, 2048, 512, 128
        return {
            "u": _w((lambda *s: torch.randn(*s, dtype=torch.bfloat16) * 0.05)(Bsz, L, D)),
            "log_A_real": _w((lambda *s: torch.randn(*s, dtype=torch.bfloat16) * 3.2)(D, N) * 0.5),
            "A_imag": _w((lambda *s: torch.randn(*s, dtype=torch.bfloat16) * 0.05)(D, N) * 3.14),
            "C_real": _w((lambda *s: torch.randn(*s, dtype=torch.bfloat16) * 0.05)(D, N) / N ** 0.5),
            "C_imag": _w((lambda *s: torch.randn(*s, dtype=torch.bfloat16) * 0.1)(D, N) / N ** 0.5),
            "log_dt": _w((lambda *s: torch.randn(*s, dtype=torch.bfloat16) * 0.05)(D) * 0.5 - 4.0),
            "D_skip": _w((lambda *s: torch.randn(*s, dtype=torch.bfloat16) * 0.05)(D)),
        }
    _A_in = _A_setup()

    def _B_setup():
        B, S, D, F = 1, 2048, 512, 1792
        return {
            "x": _w((lambda *s: torch.randn(*s, dtype=torch.bfloat16) * 0.05)(B, S, D)),
            "w1": _w((lambda *s: torch.randn(*s, dtype=torch.bfloat16) * 0.8)(D, F) * (2.0 / D) ** 0.5),
            "w3": _w((lambda *s: torch.randn(*s, dtype=torch.bfloat16) * 0.8)(D, F) * (2.0 / D) ** 0.5),
            "w2": _w((lambda *s: torch.randn(*s, dtype=torch.bfloat16) * 0.8)(F, D) * (2.0 / F) ** 0.5),
        }
    _B_in = _B_setup()

    return {
        "A_u": _A_in["u"],
        "A_log_A_real": _A_in["log_A_real"],
        "A_A_imag": _A_in["A_imag"],
        "A_C_real": _A_in["C_real"],
        "A_C_imag": _A_in["C_imag"],
        "A_log_dt": _A_in["log_dt"],
        "A_D_skip": _A_in["D_skip"],
        "B_x": _B_in["x"],
        "B_w1": _B_in["w1"],
        "B_w3": _B_in["w3"],
        "B_w2": _B_in["w2"],
        "gate_w": _w((lambda *s: torch.randn(*s, dtype=torch.bfloat16) * 0.05)(512) * 16.0),
    }

def reference(A_u, A_log_A_real, A_A_imag, A_C_real, A_C_imag, A_log_dt, A_D_skip, B_x, B_w1, B_w3, B_w2, gate_w):
    def _A_ref(u, log_A_real, A_imag, C_real, C_imag, log_dt, D_skip):
        L = u.shape[1]
        dt = torch.exp(log_dt)
        A = -torch.exp(log_A_real) + 1j * A_imag
        C = (C_real + 1j * C_imag) * dt[:, None]
        pos = (lambda x, dt: x.to(dt))(torch.arange(L), log_dt.dtype)
        P = torch.exp((A * dt[:, None])[:, :, None] * pos[None, None, :])
        K = 2.0 * torch.einsum("dn,dnl->dl", C, P).real
        L2 = 2 * L
        u_t = (lambda x, *d: x.permute(*d))(u, 0, 2, 1)
        Kf = (lambda x, *a, **k: torch.fft.rfft(x.float(), *a, **k))(K, L2)
        Uf = (lambda x, *a, **k: torch.fft.rfft(x.float(), *a, **k))(u_t, L2)
        y = (lambda x, *a, **k: torch.fft.irfft(x, *a, **k).to(torch.bfloat16))(Uf * Kf[None, :, :], L2)[:, :, :L]
        y = (lambda x, *d: x.permute(*d))(y, 0, 2, 1)
        return y + u * D_skip[None, None, :]

    def _B_ref(x, w1, w3, w2):
        gate = torch.einsum("bsd,df->bsf", x, w1)
        up = torch.einsum("bsd,df->bsf", x, w3)
        h = _silu(gate) * up
        out = torch.einsum("bsf,fd->bsd", h, w2)
        return out

    x = A_u
    g = _sigmoid((x * gate_w).sum(-1, keepdims=True))
    a = _A_ref(x, A_log_A_real, A_A_imag, A_C_real, A_C_imag, A_log_dt, A_D_skip)
    b = _B_ref(x, B_w1, B_w3, B_w2)
    return g * a + (1 - g) * b
```

```asm
; @launch grid=(256,1,1) block=(256,1,1) lds=163840
.amdgcn_target "amdgcn-amd-amdhsa--gfx950"
.text
.globl gated_mix__ssm_conv_s4d__glu_gated_swiglu__prompt_kernel
.p2align 8
.type gated_mix__ssm_conv_s4d__glu_gated_swiglu__prompt_kernel,@function
gated_mix__ssm_conv_s4d__glu_gated_swiglu__prompt_kernel:
    s_cmp_ge_u32 s2, 256
    s_cbranch_scc1 L_end
    s_load_dwordx16 s[4:19], s[0:1], 0
    s_load_dwordx8 s[20:27], s[0:1], 64
    s_load_dwordx2 s[28:29], s[0:1], 96
    s_load_dwordx2 s[30:31], s[0:1], 112
    s_getpc_b64 s[68:69]
    s_lshr_b32 s53, s2, 3
    v_lshrrev_b32 v23, 4, v0
    s_lshl_b32 s58, s53, 11
    v_lshl_add_u32 v23, v23, 7, s58
    v_min_u32 v23, 0x8a00, v23
    global_load_dword v70, v23, s[68:69]
    v_lshrrev_b32 v22, 7, v0
    v_and_b32 v1, 63, v0
    v_lshl_add_u32 v22, s2, 1, v22
    v_lshlrev_b32 v46, 2, v1
    v_lshlrev_b32 v26, 1, v22
    v_lshl_add_u32 v25, v22, 8, v46
    v_mov_b32_e64 v47, 0
    s_waitcnt lgkmcnt(0)
    global_load_ushort v68, v26, s[14:15]
    global_load_dword v64, v25, s[6:7]
    global_load_dword v65, v25, s[8:9]
    global_load_dword v66, v25, s[10:11]
    global_load_dword v67, v25, s[12:13]
    global_load_ushort v69, v26, s[16:17]
    global_load_dword v3, v47, s[30:31]
    v_lshrrev_b32_e64 v22, 6, v0
    s_and_b32 s52, s2, 7
    v_readfirstlane_b32 s3, v22
    v_lshlrev_b32 v2, 4, v1
    s_mov_b32 s32, s4
    s_mov_b32 s33, s5
    s_mov_b32 s34, 0x200000
    s_mov_b32 s35, 0x20000
    v_lshrrev_b32 v28, 4, v1
    v_lshrrev_b32 v30, 3, v1
    v_and_b32 v29, 7, v1
    v_xor_b32 v29, v29, v28
    v_lshlrev_b32 v29, 4, v29
    v_lshl_add_u32 v12, v30, 10, v29
    v_xor_b32 v13, 64, v12
    v_add_u32 v14, 14336, v12
    v_add_u32 v15, 21504, v13
    v_add_u32 v13, 7168, v13
    s_lshr_b32 s54, s52, 1
    s_lshl_b32 s54, s54, 2
    s_and_b32 s58, s53, 3
    s_add_u32 s54, s54, s58
    s_lshl_b32 s65, s54, 2
    s_add_u32 s65, s65, s3
    s_lshl_b32 s65, s65, 15
    s_lshl_b32 s67, s3, 12
    s_cmp_ge_u32 s53, 28
    s_cbranch_scc1 L_aux
    s_add_u32 m0, s67, 32768
    s_nop 0
    buffer_load_dwordx4 v12, s[32:35], s65 offen offset:0 lds
    s_lshr_b32 s76, s3, 1
    s_and_b32 s77, s3, 1
    s_cmp_eq_u32 s77, 0
    s_cselect_b64 s[36:37], s[20:21], s[22:23]
    s_mov_b32 s38, 0x1c0000
    s_mov_b32 s39, 0x20000
    s_lshr_b32 s55, s53, 2
    s_and_b32 s58, s55, 3
    s_add_u32 s58, s58, 1
    s_and_b32 s58, s58, 4
    s_xor_b32 s57, s55, s58
    s_and_b32 s59, s52, 1
    s_mul_i32 s59, s59, 7
    s_add_u32 s55, s55, s59
    s_lshl_b32 s56, s52, 2
    s_and_b32 s58, s53, 3
    s_add_u32 s56, s56, s58
    v_and_b32 v29, 15, v1
    buffer_load_dwordx4 v13, s[32:35], s65 offen offset:1024 lds
    v_lshlrev_b32 v30, 1, v28
    v_xor_b32 v29, v29, v30
    s_movk_i32 s58, 3584
    v_lshlrev_b32 v29, 4, v29
    v_mad_u32_u24 v4, v28, s58, v29
    v_xor_b32 v29, 128, v29
    buffer_load_dwordx4 v14, s[32:35], s65 offen offset:2048 lds
    v_mad_u32_u24 v31, v28, s58, v29
    v_add_u32 v5, 13312, v4
    v_add_u32 v6, 26624, v31
    v_add_u32 v7, 39936, v31
    v_add_u32 v8, 57344, v4
    v_add_u32 v9, 70656, v4
    buffer_load_dwordx4 v15, s[32:35], s65 offen offset:3072 lds
    v_add_u32 v10, 83968, v31
    v_add_u32 v11, 97280, v31
    s_mul_i32 s64, s76, 114688
    s_lshl_b32 s59, s55, 8
    s_add_u32 s64, s64, s59
    s_lshl_b32 s66, s77, 14
    s_add_u32 s65, s65, 128
    s_lshl_b32 s60, s76, 13
    s_add_u32 s66, s66, s60
    s_mul_i32 s58, s76, 31680
    s_add_u32 m0, s66, 0
    s_add_u32 s58, s58, 98304
    s_mul_i32 s59, s77, 14784
    s_add_u32 s59, s59, s58
    v_lshl_add_u32 v224, v1, 3, s59
    v_add_u32 v225, 2112, v224
    v_add_u32 v226, 4224, v224
    s_nop 0
    buffer_load_dwordx4 v4, s[36:39], s64 offen offset:0 lds
    v_add_u32 v227, 6336, v224
    v_add_u32 v228, 8448, v224
    v_add_u32 v229, 10560, v224
    v_add_u32 v230, 12672, v224
    v_add_u32 v231, 14784, v224
    v_and_b32_e64 v22, 31, v1
    buffer_load_dwordx4 v5, s[36:39], s64 offen offset:1024 lds
    v_lshrrev_b32 v23, 5, v1
    v_lshlrev_b32 v23, 4, v23
    s_lshl_b32 s59, s77, 8
    s_add_u32 s58, s58, s59
    v_add_u32 v23, s58, v23
    s_movk_i32 s59, 528
    v_mad_u32_u24 v113, v22, s59, v23
    v_writelane_b32 v22, 4, 5
    v_writelane_b32 v22, 4, 37
    v_writelane_b32 v22, 7, 12
    v_writelane_b32 v22, 7, 44
    v_writelane_b32 v22, 7, 13
    buffer_load_dwordx4 v6, s[36:39], s64 offen offset:2048 lds
    v_writelane_b32 v22, 7, 45
    v_writelane_b32 v22, 15, 20
    v_writelane_b32 v22, 15, 52
    v_writelane_b32 v22, 5, 28
    v_writelane_b32 v22, 5, 60
    v_writelane_b32 v22, 12, 29
    v_writelane_b32 v22, 12, 61
    v_writelane_b32 v22, 13, 30
    v_writelane_b32 v22, 13, 62
    v_writelane_b32 v22, 20, 31
    v_writelane_b32 v22, 20, 63
    v_mad_u32_u24 v112, v22, s59, v23
    buffer_load_dwordx4 v7, s[36:39], s64 offen offset:3072 lds
    s_mov_b32 s40, s30
    s_mov_b32 s41, s31
    s_mov_b32 s42, 0xe00000
    s_mov_b32 s43, 0x20000
    s_mov_b32 s44, s24
    s_mov_b32 s45, s25
    s_mov_b32 s46, 0x1c0000
    s_mov_b32 s47, 0x20000
    s_mov_b32 s48, s28
    s_mov_b32 s49, s29
    s_mov_b32 s50, 0x200000
    s_mov_b32 s51, 0x20000
    s_add_u32 m0, s66, 4096
    v_and_b32 v22, 15, v1
    v_lshrrev_b32 v23, 4, v1
    v_lshrrev_b32 v24, 1, v22
    v_xor_b32 v24, v24, v23
    v_lshlrev_b32 v24, 4, v24
    v_lshl_add_u32 v24, v22, 7, v24
    s_lshl_b32 s59, s77, 13
    buffer_load_dwordx4 v8, s[36:39], s64 offen offset:0 lds
    s_add_u32 s59, s59, 32768
    v_add_u32 v16, s59, v24
    v_xor_b32 v17, 64, v16
    v_bfe_u32 v24, v1, 2, 2
    v_lshl_add_u32 v25, v23, 3, v24
    v_lshlrev_b32 v25, 8, v25
    buffer_load_dwordx4 v9, s[36:39], s64 offen offset:1024 lds
    v_and_b32 v26, 3, v1
    v_lshl_add_u32 v25, v26, 3, v25
    v_bfe_u32 v26, v1, 2, 3
    s_lshl_b32 s58, s76, 2
    v_xor_b32 v26, s58, v26
    v_lshl_add_u32 v18, v26, 5, v25
    v_xor_b32 v19, 32, v18
    v_xor_b32 v20, 64, v18
    v_xor_b32 v21, 96, v18
    s_lshr_b32 s62, s52, 1
    s_mul_i32 s60, s62, 28
    s_add_u32 s60, s60, s53
    buffer_load_dwordx4 v10, s[36:39], s64 offen offset:2048 lds
    s_lshl_b32 s60, s60, 1
    s_add_u32 s60, s60, s76
    s_sub_u32 s61, s60, 32
    s_ashr_i32 s61, s61, 31
    s_and_b32 s61, s61, 802816
    s_min_u32 s60, s60, 255
    v_and_b32 v114, 15, v1
    v_min_u32 v114, 13, v114
    v_lshlrev_b32 v114, 7, v114
    v_bfe_u32 v115, v1, 4, 1
    v_mad_u32_u24 v114, v115, s61, v114
    s_add_u32 s60, s60, 64
    buffer_load_dwordx4 v11, s[36:39], s64 offen offset:3072 lds
    s_mul_i32 s60, s60, 3584
    s_and_b32 s59, s52, 1
    s_mul_i32 s61, s59, 1792
    s_add_u32 s63, s60, s61
    s_mul_i32 s59, s59, 28
    s_add_u32 s59, s59, s53
    s_lshl_b32 s59, s59, 2
    s_add_u32 s59, s59, s3
    s_mul_i32 s59, s59, 3
    v_bfe_u32 v115, v1, 3, 2
    v_min_u32 v115, 2, v115
    v_add_u32 v115, s59, v115
    s_add_u32 s64, s64, 229376
    v_min_u32 v115, 511, v115
    v_and_b32 v116, 7, v1
    v_min_u32 v116, 3, v116
    v_lshlrev_b32 v116, 7, v116
    v_lshl_add_u32 v115, v115, 10, v116
    s_lshl_b32 s62, s62, 19
    s_cmp_eq_u32 s77, 0
    s_cbranch_scc0 L_kym
    s_waitcnt vmcnt(14)
    s_mov_b32 s68, 0x3fb8aa3b
    v_lshlrev_b32 v84, 16, v68
    v_mul_f32 v84, s68, v84
    v_exp_f32 v84, v84
    v_lshlrev_b32 v76, 16, v64
    v_and_b32 v77, 0xffff0000, v64
    v_pk_mul_f32 v[76:77], v[76:77], s[68:69] op_sel_hi:[1,0]
    v_cvt_pk_bf16_f32 v84, v84, v84
    v_exp_f32 v76, v76
    v_exp_f32 v77, v77
    v_and_b32 v84, 0xffff0000, v84
    v_cvt_pk_bf16_f32 v77, v76, v77
    v_lshlrev_b32 v78, 16, v65
    v_and_b32 v79, 0xffff0000, v65
    v_lshlrev_b32_e64 v76, 16, v77
    v_and_b32 v77, 0xffff0000, v77
    v_pk_mul_f32 v[76:77], v[76:77], v[84:85] op_sel_hi:[1,0]
    v_pk_mul_f32 v[78:79], v[78:79], v[84:85] op_sel_hi:[1,0]
    v_pk_mul_f32 v[76:77], v[76:77], s[68:69] op_sel_hi:[1,0] neg_lo:[1,0] neg_hi:[1,0]
    s_mov_b32 s68, 0x3e22f983
    v_pk_mul_f32 v[78:79], v[78:79], s[68:69] op_sel_hi:[1,0]
    v_lshlrev_b32 v80, 16, v66
    v_and_b32 v82, 0xffff0000, v66
    v_lshlrev_b32 v81, 16, v67
    v_and_b32 v83, 0xffff0000, v67
    v_add_f32 v84, v84, v84
    v_pk_mul_f32 v[80:81], v[80:81], v[84:85] op_sel_hi:[1,0]
    v_pk_mul_f32 v[82:83], v[82:83], v[84:85] op_sel_hi:[1,0]
    v_fract_f32 v98, v78
    v_fract_f32 v99, v79
    v_exp_f32 v100, v76
    v_exp_f32 v101, v77
    v_cos_f32 v88, v98
    v_sin_f32 v89, v98
    v_cos_f32 v90, v99
    v_sin_f32 v91, v99
    v_pk_mul_f32 v[88:89], v[88:89], v[100:101] op_sel_hi:[1,0]
    v_pk_mul_f32 v[90:91], v[90:91], v[100:101] op_sel:[0,1] op_sel_hi:[1,1]
    s_mov_b32 s68, 0x43800000
    v_pk_mul_f32 v[96:97], v[76:77], s[68:69] op_sel_hi:[1,0]
    v_pk_mul_f32 v[98:99], v[78:79], s[68:69] op_sel_hi:[1,0]
    v_fract_f32 v98, v98
    v_fract_f32 v99, v99
    v_exp_f32 v100, v96
    v_exp_f32 v101, v97
    v_cos_f32 v92, v98
    v_sin_f32 v93, v98
    v_cos_f32 v94, v99
    v_sin_f32 v95, v99
    v_pk_mul_f32 v[92:93], v[92:93], v[100:101] op_sel_hi:[1,0]
    v_pk_mul_f32 v[94:95], v[94:95], v[100:101] op_sel:[0,1] op_sel_hi:[1,1]
    v_cvt_pk_bf16_f32 v232, v80, -v81
    v_cvt_pk_bf16_f32 v233, v82, -v83
    v_pk_mul_f32 v[104:105], v[80:81], v[88:89] op_sel_hi:[1,0]
    v_pk_mul_f32 v[106:107], v[82:83], v[90:91] op_sel_hi:[1,0]
    v_pk_fma_f32 v[120:121], v[80:81], v[88:89], v[104:105] op_sel:[1,1,0] op_sel_hi:[0,1,1] neg_lo:[0,1,0]
    v_pk_fma_f32 v[122:123], v[82:83], v[90:91], v[106:107] op_sel:[1,1,0] op_sel_hi:[0,1,1] neg_lo:[0,1,0]
    v_cvt_pk_bf16_f32 v234, v120, -v121
    v_cvt_pk_bf16_f32 v235, v122, -v123
    ds_write2_b64 v224, v[234:235], v[232:233] offset0:66 offset1:0
    v_pk_mul_f32 v[104:105], v[120:121], v[88:89] op_sel_hi:[1,0]
    v_pk_mul_f32 v[106:107], v[122:123], v[90:91] op_sel_hi:[1,0]
    v_pk_fma_f32 v[124:125], v[120:121], v[88:89], v[104:105] op_sel:[1,1,0] op_sel_hi:[0,1,1] neg_lo:[0,1,0]
    v_pk_fma_f32 v[126:127], v[122:123], v[90:91], v[106:107] op_sel:[1,1,0] op_sel_hi:[0,1,1] neg_lo:[0,1,0]
    v_cvt_pk_bf16_f32 v236, v124, -v125
    v_cvt_pk_bf16_f32 v237, v126, -v127
    v_pk_mul_f32 v[104:105], v[124:125], v[88:89] op_sel_hi:[1,0]
    v_pk_mul_f32 v[106:107], v[126:127], v[90:91] op_sel_hi:[1,0]
    v_pk_fma_f32 v[128:129], v[124:125], v[88:89], v[104:105] op_sel:[1,1,0] op_sel_hi:[0,1,1] neg_lo:[0,1,0]
    v_pk_fma_f32 v[130:131], v[126:127], v[90:91], v[106:107] op_sel:[1,1,0] op_sel_hi:[0,1,1] neg_lo:[0,1,0]
    v_cvt_pk_bf16_f32 v238, v128, -v129
    v_cvt_pk_bf16_f32 v239, v130, -v131
    ds_write2_b64 v224, v[238:239], v[236:237] offset0:198 offset1:132
    v_pk_mul_f32 v[104:105], v[128:129], v[88:89] op_sel_hi:[1,0]
    v_pk_mul_f32 v[106:107], v[130:131], v[90:91] op_sel_hi:[1,0]
    v_pk_fma_f32 v[132:133], v[128:129], v[88:89], v[104:105] op_sel:[1,1,0] op_sel_hi:[0,1,1] neg_lo:[0,1,0]
    v_pk_fma_f32 v[134:135], v[130:131], v[90:91], v[106:107] op_sel:[1,1,0] op_sel_hi:[0,1,1] neg_lo:[0,1,0]
    v_cvt_pk_bf16_f32 v240, v132, -v133
    v_cvt_pk_bf16_f32 v241, v134, -v135
    v_pk_mul_f32 v[104:105], v[132:133], v[88:89] op_sel_hi:[1,0]
    v_pk_mul_f32 v[106:107], v[134:135], v[90:91] op_sel_hi:[1,0]
    v_pk_fma_f32 v[136:137], v[132:133], v[88:89], v[104:105] op_sel:[1,1,0] op_sel_hi:[0,1,1] neg_lo:[0,1,0]
    v_pk_fma_f32 v[138:139], v[134:135], v[90:91], v[106:107] op_sel:[1,1,0] op_sel_hi:[0,1,1] neg_lo:[0,1,0]
    buffer_load_dword v0, v114, s[36:39], s63 offen
    v_cvt_pk_bf16_f32 v242, v136, -v137
    v_cvt_pk_bf16_f32 v243, v138, -v139
    ds_write2_b64 v226, v[242:243], v[240:241] offset0:66 offset1:0
    v_pk_mul_f32 v[104:105], v[136:137], v[88:89] op_sel_hi:[1,0]
    v_pk_mul_f32 v[106:107], v[138:139], v[90:91] op_sel_hi:[1,0]
    v_pk_fma_f32 v[140:141], v[136:137], v[88:89], v[104:105] op_sel:[1,1,0] op_sel_hi:[0,1,1] neg_lo:[0,1,0]
    v_pk_fma_f32 v[142:143], v[138:139], v[90:91], v[106:107] op_sel:[1,1,0] op_sel_hi:[0,1,1] neg_lo:[0,1,0]
    v_cvt_pk_bf16_f32 v244, v140, -v141
    buffer_load_dword v0, v115, s[32:35], s62 offen offset:128
    v_cvt_pk_bf16_f32 v245, v142, -v143
    v_pk_mul_f32 v[104:105], v[140:141], v[88:89] op_sel_hi:[1,0]
    v_pk_mul_f32 v[106:107], v[142:143], v[90:91] op_sel_hi:[1,0]
    v_pk_fma_f32 v[144:145], v[140:141], v[88:89], v[104:105] op_sel:[1,1,0] op_sel_hi:[0,1,1] neg_lo:[0,1,0]
    v_pk_fma_f32 v[146:147], v[142:143], v[90:91], v[106:107] op_sel:[1,1,0] op_sel_hi:[0,1,1] neg_lo:[0,1,0]
    v_cvt_pk_bf16_f32 v246, v144, -v145
    v_cvt_pk_bf16_f32 v247, v146, -v147
    ds_write2_b64 v226, v[246:247], v[244:245] offset0:198 offset1:132
    v_pk_mul_f32 v[104:105], v[144:145], v[88:89] op_sel_hi:[1,0]
    v_pk_mul_f32 v[106:107], v[146:147], v[90:91] op_sel_hi:[1,0]
    v_pk_fma_f32 v[148:149], v[144:145], v[88:89], v[104:105] op_sel:[1,1,0] op_sel_hi:[0,1,1] neg_lo:[0,1,0]
    v_pk_fma_f32 v[150:151], v[146:147], v[90:91], v[106:107] op_sel:[1,1,0] op_sel_hi:[0,1,1] neg_lo:[0,1,0]
    v_cvt_pk_bf16_f32 v248, v148, -v149
    v_cvt_pk_bf16_f32 v249, v150, -v151
    v_pk_mul_f32 v[104:105], v[80:81], v[92:93] op_sel_hi:[1,0]
    v_pk_mul_f32 v[106:107], v[82:83], v[94:95] op_sel_hi:[1,0]
    v_pk_fma_f32 v[80:81], v[80:81], v[92:93], v[104:105] op_sel:[1,1,0] op_sel_hi:[0,1,1] neg_lo:[0,1,0]
    v_pk_fma_f32 v[82:83], v[82:83], v[94:95], v[106:107] op_sel:[1,1,0] op_sel_hi:[0,1,1] neg_lo:[0,1,0]
    v_cvt_pk_bf16_f32 v250, v80, -v81
    v_cvt_pk_bf16_f32 v251, v82, -v83
    v_pk_mul_f32 v[104:105], v[124:125], v[92:93] op_sel_hi:[1,0]
    v_pk_mul_f32 v[106:107], v[126:127], v[94:95] op_sel_hi:[1,0]
    v_pk_fma_f32 v[124:125], v[124:125], v[92:93], v[104:105] op_sel:[1,1,0] op_sel_hi:[0,1,1] neg_lo:[0,1,0]
    v_pk_fma_f32 v[126:127], v[126:127], v[94:95], v[106:107] op_sel:[1,1,0] op_sel_hi:[0,1,1] neg_lo:[0,1,0]
    v_cvt_pk_bf16_f32 v252, v124, -v125
    v_cvt_pk_bf16_f32 v253, v126, -v127
    v_pk_mul_f32 v[104:105], v[132:133], v[92:93] op_sel_hi:[1,0]
    v_pk_mul_f32 v[106:107], v[134:135], v[94:95] op_sel_hi:[1,0]
    v_pk_fma_f32 v[132:133], v[132:133], v[92:93], v[104:105] op_sel:[1,1,0] op_sel_hi:[0,1,1] neg_lo:[0,1,0]
    v_pk_fma_f32 v[134:135], v[134:135], v[94:95], v[106:107] op_sel:[1,1,0] op_sel_hi:[0,1,1] neg_lo:[0,1,0]
    v_cvt_pk_bf16_f32 v254, v132, -v133
    v_cvt_pk_bf16_f32 v255, v134, -v135
    ds_write2_b64 v225, v[254:255], v[252:253] offset0:198 offset1:132
    v_pk_mul_f32 v[104:105], v[140:141], v[92:93] op_sel_hi:[1,0]
    v_pk_mul_f32 v[106:107], v[142:143], v[94:95] op_sel_hi:[1,0]
    v_pk_fma_f32 v[140:141], v[140:141], v[92:93], v[104:105] op_sel:[1,1,0] op_sel_hi:[0,1,1] neg_lo:[0,1,0]
    v_pk_fma_f32 v[142:143], v[142:143], v[94:95], v[106:107] op_sel:[1,1,0] op_sel_hi:[0,1,1] neg_lo:[0,1,0]
    v_cvt_pk_bf16_f32 v232, v140, -v141
    v_cvt_pk_bf16_f32 v233, v142, -v143
    v_pk_mul_f32 v[104:105], v[148:149], v[92:93] op_sel_hi:[1,0]
    v_pk_mul_f32 v[106:107], v[150:151], v[94:95] op_sel_hi:[1,0]
    v_pk_fma_f32 v[148:149], v[148:149], v[92:93], v[104:105] op_sel:[1,1,0] op_sel_hi:[0,1,1] neg_lo:[0,1,0]
    v_pk_fma_f32 v[150:151], v[150:151], v[94:95], v[106:107] op_sel:[1,1,0] op_sel_hi:[0,1,1] neg_lo:[0,1,0]
    v_cvt_pk_bf16_f32 v234, v148, -v149
    v_cvt_pk_bf16_f32 v235, v150, -v151
    ds_write2_b64 v227, v[234:235], v[232:233] offset0:198 offset1:132
    v_pk_mul_f32 v[104:105], v[80:81], v[92:93] op_sel_hi:[1,0]
    v_pk_mul_f32 v[106:107], v[82:83], v[94:95] op_sel_hi:[1,0]
    v_pk_fma_f32 v[80:81], v[80:81], v[92:93], v[104:105] op_sel:[1,1,0] op_sel_hi:[0,1,1] neg_lo:[0,1,0]
    v_pk_fma_f32 v[82:83], v[82:83], v[94:95], v[106:107] op_sel:[1,1,0] op_sel_hi:[0,1,1] neg_lo:[0,1,0]
    v_cvt_pk_bf16_f32 v236, v80, -v81
    v_cvt_pk_bf16_f32 v237, v82, -v83
    ds_write2_b64 v228, v[236:237], v[248:249] offset0:66 offset1:0
    v_pk_mul_f32 v[104:105], v[132:133], v[92:93] op_sel_hi:[1,0]
    v_pk_mul_f32 v[106:107], v[134:135], v[94:95] op_sel_hi:[1,0]
    v_pk_fma_f32 v[132:133], v[132:133], v[92:93], v[104:105] op_sel:[1,1,0] op_sel_hi:[0,1,1] neg_lo:[0,1,0]
    v_pk_fma_f32 v[134:135], v[134:135], v[94:95], v[106:107] op_sel:[1,1,0] op_sel_hi:[0,1,1] neg_lo:[0,1,0]
    v_cvt_pk_bf16_f32 v238, v132, -v133
    v_cvt_pk_bf16_f32 v239, v134, -v135
    v_pk_mul_f32 v[104:105], v[148:149], v[92:93] op_sel_hi:[1,0]
    v_pk_mul_f32 v[106:107], v[150:151], v[94:95] op_sel_hi:[1,0]
    v_pk_fma_f32 v[148:149], v[148:149], v[92:93], v[104:105] op_sel:[1,1,0] op_sel_hi:[0,1,1] neg_lo:[0,1,0]
    v_pk_fma_f32 v[150:151], v[150:151], v[94:95], v[106:107] op_sel:[1,1,0] op_sel_hi:[0,1,1] neg_lo:[0,1,0]
    v_cvt_pk_bf16_f32 v240, v148, -v149
    v_cvt_pk_bf16_f32 v241, v150, -v151
    ds_write2_b64 v228, v[240:241], v[238:239] offset0:198 offset1:132
    v_pk_mul_f32 v[104:105], v[80:81], v[92:93] op_sel_hi:[1,0]
    v_pk_mul_f32 v[106:107], v[82:83], v[94:95] op_sel_hi:[1,0]
    v_pk_fma_f32 v[80:81], v[80:81], v[92:93], v[104:105] op_sel:[1,1,0] op_sel_hi:[0,1,1] neg_lo:[0,1,0]
    v_pk_fma_f32 v[82:83], v[82:83], v[94:95], v[106:107] op_sel:[1,1,0] op_sel_hi:[0,1,1] neg_lo:[0,1,0]
    v_cvt_pk_bf16_f32 v242, v80, -v81
    v_cvt_pk_bf16_f32 v243, v82, -v83
    v_pk_mul_f32 v[104:105], v[132:133], v[92:93] op_sel_hi:[1,0]
    v_pk_mul_f32 v[106:107], v[134:135], v[94:95] op_sel_hi:[1,0]
    v_pk_fma_f32 v[132:133], v[132:133], v[92:93], v[104:105] op_sel:[1,1,0] op_sel_hi:[0,1,1] neg_lo:[0,1,0]
    v_pk_fma_f32 v[134:135], v[134:135], v[94:95], v[106:107] op_sel:[1,1,0] op_sel_hi:[0,1,1] neg_lo:[0,1,0]
    v_cvt_pk_bf16_f32 v244, v132, -v133
    v_cvt_pk_bf16_f32 v245, v134, -v135
    ds_write2_b64 v229, v[244:245], v[242:243] offset0:132 offset1:66
    v_pk_mul_f32 v[104:105], v[148:149], v[92:93] op_sel_hi:[1,0]
    v_pk_mul_f32 v[106:107], v[150:151], v[94:95] op_sel_hi:[1,0]
    v_pk_fma_f32 v[148:149], v[148:149], v[92:93], v[104:105] op_sel:[1,1,0] op_sel_hi:[0,1,1] neg_lo:[0,1,0]
    v_pk_fma_f32 v[150:151], v[150:151], v[94:95], v[106:107] op_sel:[1,1,0] op_sel_hi:[0,1,1] neg_lo:[0,1,0]
    v_cvt_pk_bf16_f32 v246, v148, -v149
    v_cvt_pk_bf16_f32 v247, v150, -v151
    v_pk_mul_f32 v[104:105], v[80:81], v[92:93] op_sel_hi:[1,0]
    v_pk_mul_f32 v[106:107], v[82:83], v[94:95] op_sel_hi:[1,0]
    v_pk_fma_f32 v[80:81], v[80:81], v[92:93], v[104:105] op_sel:[1,1,0] op_sel_hi:[0,1,1] neg_lo:[0,1,0]
    v_pk_fma_f32 v[82:83], v[82:83], v[94:95], v[106:107] op_sel:[1,1,0] op_sel_hi:[0,1,1] neg_lo:[0,1,0]
    v_cvt_pk_bf16_f32 v252, v80, -v81
    v_cvt_pk_bf16_f32 v253, v82, -v83
    v_pk_mul_f32 v[104:105], v[148:149], v[92:93] op_sel_hi:[1,0]
    v_pk_mul_f32 v[106:107], v[150:151], v[94:95] op_sel_hi:[1,0]
    v_pk_fma_f32 v[148:149], v[148:149], v[92:93], v[104:105] op_sel:[1,1,0] op_sel_hi:[0,1,1] neg_lo:[0,1,0]
    v_pk_fma_f32 v[150:151], v[150:151], v[94:95], v[106:107] op_sel:[1,1,0] op_sel_hi:[0,1,1] neg_lo:[0,1,0]
    v_cvt_pk_bf16_f32 v254, v148, -v149
    v_cvt_pk_bf16_f32 v255, v150, -v151
    ds_write2_b64 v230, v[254:255], v[252:253] offset0:66 offset1:0
    v_pk_mul_f32 v[104:105], v[80:81], v[92:93] op_sel_hi:[1,0]
    v_pk_mul_f32 v[106:107], v[82:83], v[94:95] op_sel_hi:[1,0]
    v_pk_fma_f32 v[80:81], v[80:81], v[92:93], v[104:105] op_sel:[1,1,0] op_sel_hi:[0,1,1] neg_lo:[0,1,0]
    v_pk_fma_f32 v[82:83], v[82:83], v[94:95], v[106:107] op_sel:[1,1,0] op_sel_hi:[0,1,1] neg_lo:[0,1,0]
    v_cvt_pk_bf16_f32 v232, v80, -v81
    v_cvt_pk_bf16_f32 v233, v82, -v83
    v_pk_mul_f32 v[104:105], v[148:149], v[92:93] op_sel_hi:[1,0]
    v_pk_mul_f32 v[106:107], v[150:151], v[94:95] op_sel_hi:[1,0]
    v_pk_fma_f32 v[148:149], v[148:149], v[92:93], v[104:105] op_sel:[1,1,0] op_sel_hi:[0,1,1] neg_lo:[0,1,0]
    s_add_u32 m0, s67, 81920
    v_pk_fma_f32 v[150:151], v[150:151], v[94:95], v[106:107] op_sel:[1,1,0] op_sel_hi:[0,1,1] neg_lo:[0,1,0]
    v_cvt_pk_bf16_f32 v234, v148, -v149
    buffer_load_dwordx4 v12, s[32:35], s65 offen offset:0 lds
    v_cvt_pk_bf16_f32 v235, v150, -v151
    ds_write2_b64 v230, v[234:235], v[232:233] offset0:198 offset1:132
    buffer_load_dwordx4 v13, s[32:35], s65 offen offset:1024 lds
    v_pk_mul_f32 v[104:105], v[80:81], v[92:93] op_sel_hi:[1,0]
    v_pk_mul_f32 v[106:107], v[82:83], v[94:95] op_sel_hi:[1,0]
    v_pk_fma_f32 v[80:81], v[80:81], v[92:93], v[104:105] op_sel:[1,1,0] op_sel_hi:[0,1,1] neg_lo:[0,1,0]
    v_pk_fma_f32 v[82:83], v[82:83], v[94:95], v[106:107] op_sel:[1,1,0] op_sel_hi:[0,1,1] neg_lo:[0,1,0]
    v_cvt_pk_bf16_f32 v248, v80, -v81
    buffer_load_dwordx4 v14, s[32:35], s65 offen offset:2048 lds
    v_cvt_pk_bf16_f32 v249, v82, -v83
    ds_write2_b64 v225, v[248:249], v[250:251] offset0:66 offset1:0
    v_pk_mul_f32 v[104:105], v[148:149], v[92:93] op_sel_hi:[1,0]
    v_pk_mul_f32 v[106:107], v[150:151], v[94:95] op_sel_hi:[1,0]
    v_pk_fma_f32 v[148:149], v[148:149], v[92:93], v[104:105] op_sel:[1,1,0] op_sel_hi:[0,1,1] neg_lo:[0,1,0]
    buffer_load_dwordx4 v15, s[32:35], s65 offen offset:3072 lds
    v_pk_fma_f32 v[150:151], v[150:151], v[94:95], v[106:107] op_sel:[1,1,0] op_sel_hi:[0,1,1] neg_lo:[0,1,0]
    v_cvt_pk_bf16_f32 v236, v148, -v149
    v_cvt_pk_bf16_f32 v237, v150, -v151
    v_pk_mul_f32 v[104:105], v[80:81], v[92:93] op_sel_hi:[1,0]
    v_pk_mul_f32 v[106:107], v[82:83], v[94:95] op_sel_hi:[1,0]
    s_add_u32 s65, s65, 128
    v_pk_fma_f32 v[80:81], v[80:81], v[92:93], v[104:105] op_sel:[1,1,0] op_sel_hi:[0,1,1] neg_lo:[0,1,0]
    v_pk_fma_f32 v[82:83], v[82:83], v[94:95], v[106:107] op_sel:[1,1,0] op_sel_hi:[0,1,1] neg_lo:[0,1,0]
    v_cvt_pk_bf16_f32 v238, v80, -v81
    s_add_u32 m0, s66, 49152
    v_cvt_pk_bf16_f32 v239, v82, -v83
    ds_write2_b64 v227, v[238:239], v[236:237] offset0:66 offset1:0
    buffer_load_dwordx4 v4, s[36:39], s64 offen offset:0 lds
    v_pk_mul_f32 v[104:105], v[148:149], v[92:93] op_sel_hi:[1,0]
    v_pk_mul_f32 v[106:107], v[150:151], v[94:95] op_sel_hi:[1,0]
    v_pk_fma_f32 v[148:149], v[148:149], v[92:93], v[104:105] op_sel:[1,1,0] op_sel_hi:[0,1,1] neg_lo:[0,1,0]
    buffer_load_dwordx4 v5, s[36:39], s64 offen offset:1024 lds
    v_pk_fma_f32 v[150:151], v[150:151], v[94:95], v[106:107] op_sel:[1,1,0] op_sel_hi:[0,1,1] neg_lo:[0,1,0]
    v_cvt_pk_bf16_f32 v240, v148, -v149
    v_cvt_pk_bf16_f32 v241, v150, -v151
    ds_write2_b64 v229, v[240:241], v[246:247] offset0:0 offset1:198
    s_branch L_kjm
.p2align 12
L_kym:
    s_waitcnt vmcnt(14)
    s_mov_b32 s68, 0x3fb8aa3b
    v_lshlrev_b32 v84, 16, v68
    v_mul_f32 v84, s68, v84
    v_exp_f32 v84, v84
    v_lshlrev_b32 v76, 16, v64
    v_and_b32 v77, 0xffff0000, v64
    v_pk_mul_f32 v[76:77], v[76:77], s[68:69] op_sel_hi:[1,0]
    v_cvt_pk_bf16_f32 v84, v84, v84
    v_exp_f32 v76, v76
    v_exp_f32 v77, v77
    v_and_b32 v84, 0xffff0000, v84
    v_cvt_pk_bf16_f32 v77, v76, v77
    v_lshlrev_b32 v78, 16, v65
    v_and_b32 v79, 0xffff0000, v65
    v_lshlrev_b32 v76, 16, v77
    v_and_b32 v77, 0xffff0000, v77
    v_pk_mul_f32 v[76:77], v[76:77], v[84:85] op_sel_hi:[1,0]
    v_pk_mul_f32 v[78:79], v[78:79], v[84:85] op_sel_hi:[1,0]
    v_pk_mul_f32 v[76:77], v[76:77], s[68:69] op_sel_hi:[1,0] neg_lo:[1,0] neg_hi:[1,0]
    s_mov_b32 s68, 0x3e22f983
    v_pk_mul_f32 v[78:79], v[78:79], s[68:69] op_sel_hi:[1,0]
    s_mov_b32 s68, 0x41000000
    v_pk_mul_f32 v[96:97], v[76:77], s[68:69] op_sel_hi:[1,0]
    v_pk_mul_f32 v[98:99], v[78:79], s[68:69] op_sel_hi:[1,0]
    v_fract_f32 v98, v98
    v_fract_f32 v99, v99
    v_exp_f32 v100, v96
    v_exp_f32 v101, v97
    v_cos_f32 v88, v98
    v_sin_f32 v89, v98
    v_cos_f32 v90, v99
    v_sin_f32 v91, v99
    v_pk_mul_f32 v[88:89], v[88:89], v[100:101] op_sel_hi:[1,0]
    v_pk_mul_f32 v[90:91], v[90:91], v[100:101] op_sel:[0,1] op_sel_hi:[1,1]
    v_mov_b32 v232, 0x3f80
    v_mov_b32 v233, 0x3f80
    v_cvt_pk_bf16_f32 v234, v88, v89
    v_cvt_pk_bf16_f32 v235, v90, v91
    ds_write2_b64 v231, v[234:235], v[232:233] offset0:132 offset1:198
    v_pk_mul_f32 v[104:105], v[88:89], v[88:89] op_sel_hi:[1,0]
    v_pk_mul_f32 v[106:107], v[90:91], v[90:91] op_sel_hi:[1,0]
    v_pk_fma_f32 v[92:93], v[88:89], v[88:89], v[104:105] op_sel:[1,1,0] op_sel_hi:[0,1,1] neg_lo:[0,1,0]
    v_pk_fma_f32 v[94:95], v[90:91], v[90:91], v[106:107] op_sel:[1,1,0] op_sel_hi:[0,1,1] neg_lo:[0,1,0]
    v_cvt_pk_bf16_f32 v236, v92, v93
    v_cvt_pk_bf16_f32 v237, v94, v95
    v_pk_mul_f32 v[104:105], v[92:93], v[88:89] op_sel_hi:[1,0]
    v_pk_mul_f32 v[106:107], v[94:95], v[90:91] op_sel_hi:[1,0]
    v_pk_fma_f32 v[92:93], v[92:93], v[88:89], v[104:105] op_sel:[1,1,0] op_sel_hi:[0,1,1] neg_lo:[0,1,0]
    v_pk_fma_f32 v[94:95], v[94:95], v[90:91], v[106:107] op_sel:[1,1,0] op_sel_hi:[0,1,1] neg_lo:[0,1,0]
    v_cvt_pk_bf16_f32 v238, v92, v93
    v_cvt_pk_bf16_f32 v239, v94, v95
    ds_write2_b64 v231, v[238:239], v[236:237] offset0:0 offset1:66
    v_pk_mul_f32 v[104:105], v[92:93], v[88:89] op_sel_hi:[1,0]
    v_pk_mul_f32 v[106:107], v[94:95], v[90:91] op_sel_hi:[1,0]
    v_pk_fma_f32 v[92:93], v[92:93], v[88:89], v[104:105] op_sel:[1,1,0] op_sel_hi:[0,1,1] neg_lo:[0,1,0]
    v_pk_fma_f32 v[94:95], v[94:95], v[90:91], v[106:107] op_sel:[1,1,0] op_sel_hi:[0,1,1] neg_lo:[0,1,0]
    v_cvt_pk_bf16_f32 v240, v92, v93
    v_cvt_pk_bf16_f32 v241, v94, v95
    v_pk_mul_f32 v[104:105], v[92:93], v[88:89] op_sel_hi:[1,0]
    v_pk_mul_f32 v[106:107], v[94:95], v[90:91] op_sel_hi:[1,0]
    v_pk_fma_f32 v[92:93], v[92:93], v[88:89], v[104:105] op_sel:[1,1,0] op_sel_hi:[0,1,1] neg_lo:[0,1,0]
    v_pk_fma_f32 v[94:95], v[94:95], v[90:91], v[106:107] op_sel:[1,1,0] op_sel_hi:[0,1,1] neg_lo:[0,1,0]
    v_cvt_pk_bf16_f32 v242, v92, v93
    v_cvt_pk_bf16_f32 v243, v94, v95
    ds_write2_b64 v230, v[242:243], v[240:241] offset0:132 offset1:198
    v_pk_mul_f32 v[104:105], v[92:93], v[88:89] op_sel_hi:[1,0]
    v_pk_mul_f32 v[106:107], v[94:95], v[90:91] op_sel_hi:[1,0]
    v_pk_fma_f32 v[92:93], v[92:93], v[88:89], v[104:105] op_sel:[1,1,0] op_sel_hi:[0,1,1] neg_lo:[0,1,0]
    v_pk_fma_f32 v[94:95], v[94:95], v[90:91], v[106:107] op_sel:[1,1,0] op_sel_hi:[0,1,1] neg_lo:[0,1,0]
    v_cvt_pk_bf16_f32 v244, v92, v93
    v_cvt_pk_bf16_f32 v245, v94, v95
    v_pk_mul_f32 v[104:105], v[92:93], v[88:89] op_sel_hi:[1,0]
    v_pk_mul_f32 v[106:107], v[94:95], v[90:91] op_sel_hi:[1,0]
    v_pk_fma_f32 v[92:93], v[92:93], v[88:89], v[104:105] op_sel:[1,1,0] op_sel_hi:[0,1,1] neg_lo:[0,1,0]
    v_pk_fma_f32 v[94:95], v[94:95], v[90:91], v[106:107] op_sel:[1,1,0] op_sel_hi:[0,1,1] neg_lo:[0,1,0]
    v_cvt_pk_bf16_f32 v246, v92, v93
    v_cvt_pk_bf16_f32 v247, v94, v95
    ds_write2_b64 v230, v[246:247], v[244:245] offset0:0 offset1:66
    v_pk_mul_f32 v[104:105], v[92:93], v[88:89] op_sel_hi:[1,0]
    v_pk_mul_f32 v[106:107], v[94:95], v[90:91] op_sel_hi:[1,0]
    v_pk_fma_f32 v[92:93], v[92:93], v[88:89], v[104:105] op_sel:[1,1,0] op_sel_hi:[0,1,1] neg_lo:[0,1,0]
    v_pk_fma_f32 v[94:95], v[94:95], v[90:91], v[106:107] op_sel:[1,1,0] op_sel_hi:[0,1,1] neg_lo:[0,1,0]
    v_cvt_pk_bf16_f32 v248, v92, v93
    v_cvt_pk_bf16_f32 v249, v94, v95
    buffer_load_dword v0, v114, s[36:39], s63 offen
    v_pk_mul_f32 v[104:105], v[92:93], v[88:89] op_sel_hi:[1,0]
    v_pk_mul_f32 v[106:107], v[94:95], v[90:91] op_sel_hi:[1,0]
    v_pk_fma_f32 v[92:93], v[92:93], v[88:89], v[104:105] op_sel:[1,1,0] op_sel_hi:[0,1,1] neg_lo:[0,1,0]
    v_pk_fma_f32 v[94:95], v[94:95], v[90:91], v[106:107] op_sel:[1,1,0] op_sel_hi:[0,1,1] neg_lo:[0,1,0]
    v_cvt_pk_bf16_f32 v250, v92, v93
    v_cvt_pk_bf16_f32 v251, v94, v95
    ds_write2_b64 v229, v[250:251], v[248:249] offset0:132 offset1:198
    v_pk_mul_f32 v[104:105], v[92:93], v[88:89] op_sel_hi:[1,0]
    buffer_load_dword v0, v115, s[32:35], s62 offen offset:128
    v_pk_mul_f32 v[106:107], v[94:95], v[90:91] op_sel_hi:[1,0]
    v_pk_fma_f32 v[92:93], v[92:93], v[88:89], v[104:105] op_sel:[1,1,0] op_sel_hi:[0,1,1] neg_lo:[0,1,0]
    v_pk_fma_f32 v[94:95], v[94:95], v[90:91], v[106:107] op_sel:[1,1,0] op_sel_hi:[0,1,1] neg_lo:[0,1,0]
    v_cvt_pk_bf16_f32 v252, v92, v93
    v_cvt_pk_bf16_f32 v253, v94, v95
    v_pk_mul_f32 v[104:105], v[92:93], v[88:89] op_sel_hi:[1,0]
    v_pk_mul_f32 v[106:107], v[94:95], v[90:91] op_sel_hi:[1,0]
    v_pk_fma_f32 v[92:93], v[92:93], v[88:89], v[104:105] op_sel:[1,1,0] op_sel_hi:[0,1,1] neg_lo:[0,1,0]
    v_pk_fma_f32 v[94:95], v[94:95], v[90:91], v[106:107] op_sel:[1,1,0] op_sel_hi:[0,1,1] neg_lo:[0,1,0]
    v_cvt_pk_bf16_f32 v254, v92, v93
    v_cvt_pk_bf16_f32 v255, v94, v95
    ds_write2_b64 v229, v[254:255], v[252:253] offset0:0 offset1:66
    v_pk_mul_f32 v[104:105], v[92:93], v[88:89] op_sel_hi:[1,0]
    v_pk_mul_f32 v[106:107], v[94:95], v[90:91] op_sel_hi:[1,0]
    v_pk_fma_f32 v[92:93], v[92:93], v[88:89], v[104:105] op_sel:[1,1,0] op_sel_hi:[0,1,1] neg_lo:[0,1,0]
    v_pk_fma_f32 v[94:95], v[94:95], v[90:91], v[106:107] op_sel:[1,1,0] op_sel_hi:[0,1,1] neg_lo:[0,1,0]
    v_cvt_pk_bf16_f32 v232, v92, v93
    v_cvt_pk_bf16_f32 v233, v94, v95
    v_pk_mul_f32 v[104:105], v[92:93], v[88:89] op_sel_hi:[1,0]
    v_pk_mul_f32 v[106:107], v[94:95], v[90:91] op_sel_hi:[1,0]
    v_pk_fma_f32 v[92:93], v[92:93], v[88:89], v[104:105] op_sel:[1,1,0] op_sel_hi:[0,1,1] neg_lo:[0,1,0]
    v_pk_fma_f32 v[94:95], v[94:95], v[90:91], v[106:107] op_sel:[1,1,0] op_sel_hi:[0,1,1] neg_lo:[0,1,0]
    v_cvt_pk_bf16_f32 v234, v92, v93
    v_cvt_pk_bf16_f32 v235, v94, v95
    ds_write2_b64 v228, v[234:235], v[232:233] offset0:132 offset1:198
    v_pk_mul_f32 v[104:105], v[92:93], v[88:89] op_sel_hi:[1,0]
    v_pk_mul_f32 v[106:107], v[94:95], v[90:91] op_sel_hi:[1,0]
    v_pk_fma_f32 v[92:93], v[92:93], v[88:89], v[104:105] op_sel:[1,1,0] op_sel_hi:[0,1,1] neg_lo:[0,1,0]
    v_pk_fma_f32 v[94:95], v[94:95], v[90:91], v[106:107] op_sel:[1,1,0] op_sel_hi:[0,1,1] neg_lo:[0,1,0]
    v_cvt_pk_bf16_f32 v236, v92, v93
    v_cvt_pk_bf16_f32 v237, v94, v95
    v_pk_mul_f32 v[104:105], v[92:93], v[88:89] op_sel_hi:[1,0]
    v_pk_mul_f32 v[106:107], v[94:95], v[90:91] op_sel_hi:[1,0]
    v_pk_fma_f32 v[92:93], v[92:93], v[88:89], v[104:105] op_sel:[1,1,0] op_sel_hi:[0,1,1] neg_lo:[0,1,0]
    v_pk_fma_f32 v[94:95], v[94:95], v[90:91], v[106:107] op_sel:[1,1,0] op_sel_hi:[0,1,1] neg_lo:[0,1,0]
    v_cvt_pk_bf16_f32 v238, v92, v93
    v_cvt_pk_bf16_f32 v239, v94, v95
    ds_write2_b64 v228, v[238:239], v[236:237] offset0:0 offset1:66
    v_pk_mul_f32 v[104:105], v[92:93], v[88:89] op_sel_hi:[1,0]
    v_pk_mul_f32 v[106:107], v[94:95], v[90:91] op_sel_hi:[1,0]
    v_pk_fma_f32 v[92:93], v[92:93], v[88:89], v[104:105] op_sel:[1,1,0] op_sel_hi:[0,1,1] neg_lo:[0,1,0]
    v_pk_fma_f32 v[94:95], v[94:95], v[90:91], v[106:107] op_sel:[1,1,0] op_sel_hi:[0,1,1] neg_lo:[0,1,0]
    v_cvt_pk_bf16_f32 v240, v92, v93
    v_cvt_pk_bf16_f32 v241, v94, v95
    v_pk_mul_f32 v[104:105], v[92:93], v[88:89] op_sel_hi:[1,0]
    v_pk_mul_f32 v[106:107], v[94:95], v[90:91] op_sel_hi:[1,0]
    v_pk_fma_f32 v[92:93], v[92:93], v[88:89], v[104:105] op_sel:[1,1,0] op_sel_hi:[0,1,1] neg_lo:[0,1,0]
    v_pk_fma_f32 v[94:95], v[94:95], v[90:91], v[106:107] op_sel:[1,1,0] op_sel_hi:[0,1,1] neg_lo:[0,1,0]
    v_cvt_pk_bf16_f32 v242, v92, v93
    v_cvt_pk_bf16_f32 v243, v94, v95
    ds_write2_b64 v227, v[242:243], v[240:241] offset0:132 offset1:198
    v_pk_mul_f32 v[104:105], v[92:93], v[88:89] op_sel_hi:[1,0]
    v_pk_mul_f32 v[106:107], v[94:95], v[90:91] op_sel_hi:[1,0]
    v_pk_fma_f32 v[92:93], v[92:93], v[88:89], v[104:105] op_sel:[1,1,0] op_sel_hi:[0,1,1] neg_lo:[0,1,0]
    v_pk_fma_f32 v[94:95], v[94:95], v[90:91], v[106:107] op_sel:[1,1,0] op_sel_hi:[0,1,1] neg_lo:[0,1,0]
    v_cvt_pk_bf16_f32 v244, v92, v93
    v_cvt_pk_bf16_f32 v245, v94, v95
    v_pk_mul_f32 v[104:105], v[92:93], v[88:89] op_sel_hi:[1,0]
    v_pk_mul_f32 v[106:107], v[94:95], v[90:91] op_sel_hi:[1,0]
    v_pk_fma_f32 v[92:93], v[92:93], v[88:89], v[104:105] op_sel:[1,1,0] op_sel_hi:[0,1,1] neg_lo:[0,1,0]
    v_pk_fma_f32 v[94:95], v[94:95], v[90:91], v[106:107] op_sel:[1,1,0] op_sel_hi:[0,1,1] neg_lo:[0,1,0]
    v_cvt_pk_bf16_f32 v246, v92, v93
    v_cvt_pk_bf16_f32 v247, v94, v95
    ds_write2_b64 v227, v[246:247], v[244:245] offset0:0 offset1:66
    v_pk_mul_f32 v[104:105], v[92:93], v[88:89] op_sel_hi:[1,0]
    v_pk_mul_f32 v[106:107], v[94:95], v[90:91] op_sel_hi:[1,0]
    v_pk_fma_f32 v[92:93], v[92:93], v[88:89], v[104:105] op_sel:[1,1,0] op_sel_hi:[0,1,1] neg_lo:[0,1,0]
    v_pk_fma_f32 v[94:95], v[94:95], v[90:91], v[106:107] op_sel:[1,1,0] op_sel_hi:[0,1,1] neg_lo:[0,1,0]
    v_cvt_pk_bf16_f32 v248, v92, v93
    v_cvt_pk_bf16_f32 v249, v94, v95
    v_pk_mul_f32 v[104:105], v[92:93], v[88:89] op_sel_hi:[1,0]
    v_pk_mul_f32 v[106:107], v[94:95], v[90:91] op_sel_hi:[1,0]
    v_pk_fma_f32 v[92:93], v[92:93], v[88:89], v[104:105] op_sel:[1,1,0] op_sel_hi:[0,1,1] neg_lo:[0,1,0]
    v_pk_fma_f32 v[94:95], v[94:95], v[90:91], v[106:107] op_sel:[1,1,0] op_sel_hi:[0,1,1] neg_lo:[0,1,0]
    v_cvt_pk_bf16_f32 v250, v92, v93
    v_cvt_pk_bf16_f32 v251, v94, v95
    ds_write2_b64 v226, v[250:251], v[248:249] offset0:132 offset1:198
    v_pk_mul_f32 v[104:105], v[92:93], v[88:89] op_sel_hi:[1,0]
    v_pk_mul_f32 v[106:107], v[94:95], v[90:91] op_sel_hi:[1,0]
    v_pk_fma_f32 v[92:93], v[92:93], v[88:89], v[104:105] op_sel:[1,1,0] op_sel_hi:[0,1,1] neg_lo:[0,1,0]
    v_pk_fma_f32 v[94:95], v[94:95], v[90:91], v[106:107] op_sel:[1,1,0] op_sel_hi:[0,1,1] neg_lo:[0,1,0]
    v_cvt_pk_bf16_f32 v252, v92, v93
    v_cvt_pk_bf16_f32 v253, v94, v95
    v_pk_mul_f32 v[104:105], v[92:93], v[88:89] op_sel_hi:[1,0]
    v_pk_mul_f32 v[106:107], v[94:95], v[90:91] op_sel_hi:[1,0]
    v_pk_fma_f32 v[92:93], v[92:93], v[88:89], v[104:105] op_sel:[1,1,0] op_sel_hi:[0,1,1] neg_lo:[0,1,0]
    v_pk_fma_f32 v[94:95], v[94:95], v[90:91], v[106:107] op_sel:[1,1,0] op_sel_hi:[0,1,1] neg_lo:[0,1,0]
    v_cvt_pk_bf16_f32 v254, v92, v93
    v_cvt_pk_bf16_f32 v255, v94, v95
    ds_write2_b64 v226, v[254:255], v[252:253] offset0:0 offset1:66
    v_pk_mul_f32 v[104:105], v[92:93], v[88:89] op_sel_hi:[1,0]
    v_pk_mul_f32 v[106:107], v[94:95], v[90:91] op_sel_hi:[1,0]
    v_pk_fma_f32 v[92:93], v[92:93], v[88:89], v[104:105] op_sel:[1,1,0] op_sel_hi:[0,1,1] neg_lo:[0,1,0]
    v_pk_fma_f32 v[94:95], v[94:95], v[90:91], v[106:107] op_sel:[1,1,0] op_sel_hi:[0,1,1] neg_lo:[0,1,0]
    v_cvt_pk_bf16_f32 v232, v92, v93
    v_cvt_pk_bf16_f32 v233, v94, v95
    v_pk_mul_f32 v[104:105], v[92:93], v[88:89] op_sel_hi:[1,0]
    v_pk_mul_f32 v[106:107], v[94:95], v[90:91] op_sel_hi:[1,0]
    v_pk_fma_f32 v[92:93], v[92:93], v[88:89], v[104:105] op_sel:[1,1,0] op_sel_hi:[0,1,1] neg_lo:[0,1,0]
    v_pk_fma_f32 v[94:95], v[94:95], v[90:91], v[106:107] op_sel:[1,1,0] op_sel_hi:[0,1,1] neg_lo:[0,1,0]
    v_cvt_pk_bf16_f32 v234, v92, v93
    v_cvt_pk_bf16_f32 v235, v94, v95
    ds_write2_b64 v225, v[234:235], v[232:233] offset0:132 offset1:198
    v_pk_mul_f32 v[104:105], v[92:93], v[88:89] op_sel_hi:[1,0]
    v_pk_mul_f32 v[106:107], v[94:95], v[90:91] op_sel_hi:[1,0]
    v_pk_fma_f32 v[92:93], v[92:93], v[88:89], v[104:105] op_sel:[1,1,0] op_sel_hi:[0,1,1] neg_lo:[0,1,0]
    v_pk_fma_f32 v[94:95], v[94:95], v[90:91], v[106:107] op_sel:[1,1,0] op_sel_hi:[0,1,1] neg_lo:[0,1,0]
    v_cvt_pk_bf16_f32 v236, v92, v93
    v_cvt_pk_bf16_f32 v237, v94, v95
    v_pk_mul_f32 v[104:105], v[92:93], v[88:89] op_sel_hi:[1,0]
    s_add_u32 m0, s67, 81920
    v_pk_mul_f32 v[106:107], v[94:95], v[90:91] op_sel_hi:[1,0]
    v_pk_fma_f32 v[92:93], v[92:93], v[88:89], v[104:105] op_sel:[1,1,0] op_sel_hi:[0,1,1] neg_lo:[0,1,0]
    buffer_load_dwordx4 v12, s[32:35], s65 offen offset:0 lds
    v_pk_fma_f32 v[94:95], v[94:95], v[90:91], v[106:107] op_sel:[1,1,0] op_sel_hi:[0,1,1] neg_lo:[0,1,0]
    v_cvt_pk_bf16_f32 v238, v92, v93
    v_cvt_pk_bf16_f32 v239, v94, v95
    buffer_load_dwordx4 v13, s[32:35], s65 offen offset:1024 lds
    ds_write2_b64 v225, v[238:239], v[236:237] offset0:0 offset1:66
    v_pk_mul_f32 v[104:105], v[92:93], v[88:89] op_sel_hi:[1,0]
    v_pk_mul_f32 v[106:107], v[94:95], v[90:91] op_sel_hi:[1,0]
    v_pk_fma_f32 v[92:93], v[92:93], v[88:89], v[104:105] op_sel:[1,1,0] op_sel_hi:[0,1,1] neg_lo:[0,1,0]
    v_pk_fma_f32 v[94:95], v[94:95], v[90:91], v[106:107] op_sel:[1,1,0] op_sel_hi:[0,1,1] neg_lo:[0,1,0]
    buffer_load_dwordx4 v14, s[32:35], s65 offen offset:2048 lds
    v_cvt_pk_bf16_f32 v240, v92, v93
    v_cvt_pk_bf16_f32 v241, v94, v95
    v_pk_mul_f32 v[104:105], v[92:93], v[88:89] op_sel_hi:[1,0]
    v_pk_mul_f32 v[106:107], v[94:95], v[90:91] op_sel_hi:[1,0]
    v_pk_fma_f32 v[92:93], v[92:93], v[88:89], v[104:105] op_sel:[1,1,0] op_sel_hi:[0,1,1] neg_lo:[0,1,0]
    buffer_load_dwordx4 v15, s[32:35], s65 offen offset:3072 lds
    v_pk_fma_f32 v[94:95], v[94:95], v[90:91], v[106:107] op_sel:[1,1,0] op_sel_hi:[0,1,1] neg_lo:[0,1,0]
    v_cvt_pk_bf16_f32 v242, v92, v93
    v_cvt_pk_bf16_f32 v243, v94, v95
    ds_write2_b64 v224, v[242:243], v[240:241] offset0:132 offset1:198
    v_pk_mul_f32 v[104:105], v[92:93], v[88:89] op_sel_hi:[1,0]
    s_add_u32 s65, s65, 128
    v_pk_mul_f32 v[106:107], v[94:95], v[90:91] op_sel_hi:[1,0]
    v_pk_fma_f32 v[92:93], v[92:93], v[88:89], v[104:105] op_sel:[1,1,0] op_sel_hi:[0,1,1] neg_lo:[0,1,0]
    s_add_u32 m0, s66, 49152
    v_pk_fma_f32 v[94:95], v[94:95], v[90:91], v[106:107] op_sel:[1,1,0] op_sel_hi:[0,1,1] neg_lo:[0,1,0]
    v_cvt_pk_bf16_f32 v244, v92, v93
    v_cvt_pk_bf16_f32 v245, v94, v95
    buffer_load_dwordx4 v4, s[36:39], s64 offen offset:0 lds
    v_pk_mul_f32 v[104:105], v[92:93], v[88:89] op_sel_hi:[1,0]
    v_pk_mul_f32 v[106:107], v[94:95], v[90:91] op_sel_hi:[1,0]
    buffer_load_dwordx4 v5, s[36:39], s64 offen offset:1024 lds
    v_pk_fma_f32 v[92:93], v[92:93], v[88:89], v[104:105] op_sel:[1,1,0] op_sel_hi:[0,1,1] neg_lo:[0,1,0]
    v_pk_fma_f32 v[94:95], v[94:95], v[90:91], v[106:107] op_sel:[1,1,0] op_sel_hi:[0,1,1] neg_lo:[0,1,0]
    v_cvt_pk_bf16_f32 v246, v92, v93
    v_cvt_pk_bf16_f32 v247, v94, v95
    ds_write2_b64 v224, v[246:247], v[244:245] offset0:0 offset1:66
L_kjm:
    s_waitcnt vmcnt(20)
    v_lshlrev_b32 v69, 16, v69
    v_readfirstlane_b32 s19, v3
    v_readfirstlane_b32 s71, v69
    s_mov_b32 s0, 0
    s_mov_b64 exec, 0
    s_cmp_eq_u32 s3, 0
    s_cbranch_scc1 L_pg0
    s_cmp_eq_u32 s3, 1
    s_cbranch_scc1 L_pg1
    s_cmp_eq_u32 s3, 2
    s_cbranch_scc1 L_pg2
    s_branch L_pg3
L_pgback:
    s_mov_b64 exec, -1
    s_cmp_eq_u32 s0, 1
    s_cbranch_scc1 L_pgaux
    s_waitcnt vmcnt(8) lgkmcnt(0)
    s_mul_i32 s19, s19, 0x0019660d
    s_add_u32 s19, s19, 0x3c6ef35f
    s_barrier
    ds_read_b128 v[160:163], v112 offset:0
    ds_read_b128 v[164:167], v113 offset:14784
    ds_read_b128 v[168:171], v112 offset:32
    ds_read_b128 v[172:175], v113 offset:14816
    ds_read_b128 v[176:179], v112 offset:64
    ds_read_b128 v[180:183], v113 offset:14848
    ds_read_b128 v[184:187], v112 offset:96
    ds_read_b128 v[188:191], v113 offset:14880
    ds_read_b128 v[192:195], v112 offset:128
    ds_read_b128 v[196:199], v113 offset:14912
    ds_read_b128 v[200:203], v112 offset:160
    ds_read_b128 v[204:207], v113 offset:14944
    s_waitcnt lgkmcnt(10)
    v_mfma_f32_32x32x16_bf16 v[48:63], v[160:163], v[164:167], 0
    buffer_load_dwordx4 v6, s[36:39], s64 offen offset:2048 lds
    ds_read_b128 v[208:211], v112 offset:192
    ds_read_b128 v[212:215], v113 offset:14976
    s_waitcnt lgkmcnt(10)
    v_mfma_f32_32x32x16_bf16 v[48:63], v[168:171], v[172:175], v[48:63]
    buffer_load_dwordx4 v7, s[36:39], s64 offen offset:3072 lds
    s_add_u32 m0, s66, 53248
    ds_read_b128 v[216:219], v112 offset:224
    s_waitcnt lgkmcnt(9)
    v_mfma_f32_32x32x16_bf16 v[48:63], v[176:179], v[180:183], v[48:63]
    buffer_load_dwordx4 v8, s[36:39], s64 offen offset:0 lds
    ds_read_b128 v[220:223], v113 offset:15008
    ds_read_b64_tr_b16 v[64:65], v18 offset:0
    s_waitcnt lgkmcnt(9)
    v_mfma_f32_32x32x16_bf16 v[48:63], v[184:187], v[188:191], v[48:63]
    buffer_load_dwordx4 v9, s[36:39], s64 offen offset:1024 lds
    ds_read_b64_tr_b16 v[66:67], v18 offset:1024
    ds_read_b128 a[224:227], v16 offset:0
    s_waitcnt lgkmcnt(9)
    v_mfma_f32_32x32x16_bf16 v[48:63], v[192:195], v[196:199], v[48:63]
    buffer_load_dwordx4 v10, s[36:39], s64 offen offset:2048 lds
    ds_read_b128 a[228:231], v16 offset:2048
    ds_read_b128 a[232:235], v16 offset:4096
    s_waitcnt lgkmcnt(9)
    v_mfma_f32_32x32x16_bf16 v[48:63], v[200:203], v[204:207], v[48:63]
    buffer_load_dwordx4 v11, s[36:39], s64 offen offset:3072 lds
    s_add_u32 s64, s64, 229376
    ds_read_b128 a[236:239], v16 offset:6144
    s_waitcnt lgkmcnt(8)
    v_mfma_f32_32x32x16_bf16 v[48:63], v[208:211], v[212:215], v[48:63]
    ds_read_b64_tr_b16 v[68:69], v18 offset:16384
    ds_read_b64_tr_b16 v[70:71], v18 offset:17408
    ds_read_b64_tr_b16 v[72:73], v19 offset:0
    s_waitcnt lgkmcnt(9)
    v_mfma_f32_32x32x16_bf16 v[48:63], v[216:219], v[220:223], v[48:63]
    ds_read_b64_tr_b16 v[74:75], v19 offset:1024
    ds_read_b64_tr_b16 v[76:77], v19 offset:16384
    ds_read_b64_tr_b16 v[78:79], v19 offset:17408
    ds_read_b64_tr_b16 v[80:81], v20 offset:0
    ds_read_b64_tr_b16 v[82:83], v20 offset:1024
    ds_read_b64_tr_b16 v[84:85], v20 offset:16384
    ds_read_b64_tr_b16 v[86:87], v20 offset:17408
    ds_read_b64_tr_b16 v[88:89], v21 offset:0
    ds_read_b64_tr_b16 v[90:91], v21 offset:1024
    ds_read_b64_tr_b16 v[92:93], v21 offset:16384
    ds_read_b64_tr_b16 v[94:95], v21 offset:17408
    s_barrier
    s_lshl_b32 s58, s3, 12
    s_add_u32 s58, s58, 147456
    v_add_u32 v22, s58, v2
    v_xor_b32 v23, 4096, v22
    s_waitcnt lgkmcnt(10)
    v_mfma_f32_16x16x32_bf16 v[128:131], v[64:67], a[224:227], 0
    s_add_u32 m0, s67, 131072
    ds_read_b64_tr_b16 v[96:97], v18 offset:8192
    v_mfma_f32_16x16x32_bf16 v[132:135], v[64:67], a[228:231], 0
    buffer_load_dwordx4 v12, s[32:35], s65 offen offset:0 lds
    v_mfma_f32_16x16x32_bf16 v[136:139], v[64:67], a[232:235], 0
    ds_write_b128 v22, v[48:51] offset:0
    v_mfma_f32_16x16x32_bf16 v[140:143], v[64:67], a[236:239], 0
    v_add_u32 v16, 0xc000, v16
    ds_read_b64_tr_b16 v[98:99], v18 offset:9216
    v_mfma_f32_16x16x32_bf16 v[144:147], v[68:71], a[224:227], 0
    ds_write_b128 v22, v[52:55] offset:1024
    v_mfma_f32_16x16x32_bf16 v[148:151], v[68:71], a[228:231], 0
    buffer_load_dwordx4 v13, s[32:35], s65 offen offset:1024 lds
    v_mfma_f32_16x16x32_bf16 v[152:155], v[68:71], a[232:235], 0
    ds_write_b128 v22, v[56:59] offset:2048
    v_mfma_f32_16x16x32_bf16 v[156:159], v[68:71], a[236:239], 0
    ds_read_b128 a[240:243], v17 offset:0
    v_lshrrev_b32 v42, 3, v1
    v_mfma_f32_16x16x32_bf16 v[160:163], v[72:75], a[224:227], 0
    ds_write_b128 v22, v[60:63] offset:3072
    v_mfma_f32_16x16x32_bf16 v[164:167], v[72:75], a[228:231], 0
    buffer_load_dwordx4 v14, s[32:35], s65 offen offset:2048 lds
    v_mfma_f32_16x16x32_bf16 v[168:171], v[72:75], a[232:235], 0
    ds_read_b128 a[244:247], v17 offset:2048
    v_and_b32 v43, 7, v1
    v_mfma_f32_16x16x32_bf16 v[172:175], v[72:75], a[236:239], 0
    ds_read_b128 a[248:251], v17 offset:4096
    v_lshrrev_b32 v44, 4, v1
    s_waitcnt lgkmcnt(13)
    v_mfma_f32_16x16x32_bf16 v[176:179], v[76:79], a[224:227], 0
    ds_read_b128 a[252:255], v17 offset:6144
    v_add_u32 v17, 0xc000, v17
    v_mfma_f32_16x16x32_bf16 v[180:183], v[76:79], a[228:231], 0
    buffer_load_dwordx4 v15, s[32:35], s65 offen offset:3072 lds
    v_mfma_f32_16x16x32_bf16 v[184:187], v[76:79], a[232:235], 0
    s_add_u32 s65, s65, 128
    ds_read_b64_tr_b16 v[100:101], v18 offset:24576
    v_mfma_f32_16x16x32_bf16 v[188:191], v[76:79], a[236:239], 0
    ds_read_b64_tr_b16 v[102:103], v18 offset:25600
    v_add_u32 v18, 0xc000, v18
    v_mfma_f32_16x16x32_bf16 v[192:195], v[80:83], a[224:227], 0
    s_add_u32 m0, s66, 98304
    ds_read_b64_tr_b16 v[104:105], v19 offset:8192
    v_mfma_f32_16x16x32_bf16 v[196:199], v[80:83], a[228:231], 0
    buffer_load_dwordx4 v4, s[36:39], s64 offen offset:0 lds
    v_mfma_f32_16x16x32_bf16 v[200:203], v[80:83], a[232:235], 0
    ds_read_b64_tr_b16 v[106:107], v19 offset:9216
    v_lshlrev_b32 v44, 1, v44
    v_mfma_f32_16x16x32_bf16 v[204:207], v[80:83], a[236:239], 0
    ds_read_b64_tr_b16 v[108:109], v19 offset:24576
    v_xor_b32 v43, v43, v44
    v_mfma_f32_16x16x32_bf16 v[208:211], v[84:87], a[224:227], 0
    ds_read_b64_tr_b16 v[110:111], v19 offset:25600
    v_add_u32 v19, 0xc000, v19
    v_mfma_f32_16x16x32_bf16 v[212:215], v[84:87], a[228:231], 0
    buffer_load_dwordx4 v5, s[36:39], s64 offen offset:1024 lds
    v_mfma_f32_16x16x32_bf16 v[216:219], v[84:87], a[232:235], 0
    ds_read_b64_tr_b16 v[112:113], v20 offset:8192
    v_lshlrev_b32 v43, 4, v43
    v_mfma_f32_16x16x32_bf16 v[220:223], v[84:87], a[236:239], 0
    ds_read_b64_tr_b16 v[114:115], v20 offset:9216
    v_lshl_add_u32 v34, v42, 10, v43
    s_waitcnt lgkmcnt(15)
    v_mfma_f32_16x16x32_bf16 v[224:227], v[88:91], a[224:227], 0
    ds_read_b64_tr_b16 v[116:117], v20 offset:24576
    v_add_u32 v35, 7168, v34
    v_mfma_f32_16x16x32_bf16 v[228:231], v[88:91], a[228:231], 0
    buffer_load_dwordx4 v6, s[36:39], s64 offen offset:2048 lds
    v_mfma_f32_16x16x32_bf16 v[232:235], v[88:91], a[232:235], 0
    ds_read_b64_tr_b16 v[118:119], v20 offset:25600
    v_add_u32 v20, 0xc000, v20
    v_mfma_f32_16x16x32_bf16 v[236:239], v[88:91], a[236:239], 0
    ds_read_b64_tr_b16 v[120:121], v21 offset:8192
    v_add_u32 v36, 14336, v34
    v_mfma_f32_16x16x32_bf16 v[240:243], v[92:95], a[224:227], 0
    ds_read_b64_tr_b16 v[122:123], v21 offset:9216
    v_add_u32 v37, 21504, v34
    v_mfma_f32_16x16x32_bf16 v[244:247], v[92:95], a[228:231], 0
    buffer_load_dwordx4 v7, s[36:39], s64 offen offset:3072 lds
    v_mfma_f32_16x16x32_bf16 v[248:251], v[92:95], a[232:235], 0
    ds_read_b64_tr_b16 v[124:125], v21 offset:24576
    v_lshrrev_b32 v42, 2, v1
    v_mfma_f32_16x16x32_bf16 v[252:255], v[92:95], a[236:239], 0
    ds_read_b64_tr_b16 v[126:127], v21 offset:25600
    v_add_u32 v21, 0xc000, v21
    s_waitcnt vmcnt(8) lgkmcnt(0)
    s_barrier
    v_mfma_f32_16x16x32_bf16 v[128:131], v[96:99], a[240:243], v[128:131]
    s_add_u32 m0, s66, 102400
    ds_read_b64_tr_b16 v[64:65], v18 offset:0
    v_mfma_f32_16x16x32_bf16 v[132:135], v[96:99], a[244:247], v[132:135]
    buffer_load_dwordx4 v8, s[36:39], s64 offen offset:0 lds
    v_mfma_f32_16x16x32_bf16 v[136:139], v[96:99], a[248:251], v[136:139]
    ds_read_b64_tr_b16 v[66:67], v18 offset:1024
    v_bfe_u32 v43, v1, 3, 2
    v_mfma_f32_16x16x32_bf16 v[140:143], v[96:99], a[252:255], v[140:143]
    ds_read_b128 a[224:227], v16 offset:0
    v_and_b32 v44, 3, v1
    v_mfma_f32_16x16x32_bf16 v[144:147], v[100:103], a[240:243], v[144:147]
    ds_read_b128 a[228:231], v16 offset:2048
    v_lshlrev_b32 v42, 7, v42
    v_mfma_f32_16x16x32_bf16 v[148:151], v[100:103], a[244:247], v[148:151]
    buffer_load_dwordx4 v9, s[36:39], s64 offen offset:1024 lds
    v_mfma_f32_16x16x32_bf16 v[152:155], v[100:103], a[248:251], v[152:155]
    ds_read_b128 a[232:235], v16 offset:4096
    v_lshl_add_u32 v42, v43, 5, v42
    v_mfma_f32_16x16x32_bf16 v[156:159], v[100:103], a[252:255], v[156:159]
    ds_read_b128 a[236:239], v16 offset:6144
    v_lshl_add_u32 v42, v44, 3, v42
    v_mfma_f32_16x16x32_bf16 v[160:163], v[104:107], a[240:243], v[160:163]
    ds_read_b64_tr_b16 v[68:69], v18 offset:16384
    s_lshl_b32 s13, s3, 12
    v_mfma_f32_16x16x32_bf16 v[164:167], v[104:107], a[244:247], v[164:167]
    buffer_load_dwordx4 v10, s[36:39], s64 offen offset:2048 lds
    v_mfma_f32_16x16x32_bf16 v[168:171], v[104:107], a[248:251], v[168:171]
    ds_read_b64_tr_b16 v[70:71], v18 offset:17408
    v_add_u32 v38, s13, v42
    v_mfma_f32_16x16x32_bf16 v[172:175], v[104:107], a[252:255], v[172:175]
    ds_read_b64_tr_b16 v[72:73], v19 offset:0
    v_xor_b32 v39, 32, v38
    v_mfma_f32_16x16x32_bf16 v[176:179], v[108:111], a[240:243], v[176:179]
    ds_read_b64_tr_b16 v[74:75], v19 offset:1024
    v_xor_b32 v40, 64, v38
    v_mfma_f32_16x16x32_bf16 v[180:183], v[108:111], a[244:247], v[180:183]
    buffer_load_dwordx4 v11, s[36:39], s64 offen offset:3072 lds
    v_mfma_f32_16x16x32_bf16 v[184:187], v[108:111], a[248:251], v[184:187]
    s_add_u32 s64, s64, 229376
    ds_read_b64_tr_b16 v[76:77], v19 offset:16384
    v_mfma_f32_16x16x32_bf16 v[188:191], v[108:111], a[252:255], v[188:191]
    ds_read_b64_tr_b16 v[78:79], v19 offset:17408
    v_xor_b32 v41, 96, v38
    v_mfma_f32_16x16x32_bf16 v[192:195], v[112:115], a[240:243], v[192:195]
    s_add_u32 m0, s67, 32768
    ds_read_b64_tr_b16 v[80:81], v20 offset:0
    v_mfma_f32_16x16x32_bf16 v[196:199], v[112:115], a[244:247], v[196:199]
    buffer_load_dwordx4 v12, s[32:35], s65 offen offset:0 lds
    v_mfma_f32_16x16x32_bf16 v[200:203], v[112:115], a[248:251], v[200:203]
    ds_read_b64_tr_b16 v[82:83], v20 offset:1024
    v_add_u32 v42, 98304, v38
    v_mfma_f32_16x16x32_bf16 v[204:207], v[112:115], a[252:255], v[204:207]
    ds_read_b64_tr_b16 v[84:85], v20 offset:16384
    v_add_u32 v43, 98304, v39
    v_mfma_f32_16x16x32_bf16 v[208:211], v[116:119], a[240:243], v[208:211]
    ds_read_b64_tr_b16 v[86:87], v20 offset:17408
    v_add_u32 v44, 98304, v40
    v_mfma_f32_16x16x32_bf16 v[212:215], v[116:119], a[244:247], v[212:215]
    buffer_load_dwordx4 v13, s[32:35], s65 offen offset:1024 lds
    v_mfma_f32_16x16x32_bf16 v[216:219], v[116:119], a[248:251], v[216:219]
    ds_read_b64_tr_b16 v[88:89], v21 offset:0
    v_add_u32 v45, 98304, v41
    v_mfma_f32_16x16x32_bf16 v[220:223], v[116:119], a[252:255], v[220:223]
    ds_read_b64_tr_b16 v[90:91], v21 offset:1024
    s_mul_i32 s12, s3, 458752
    v_mfma_f32_16x16x32_bf16 v[224:227], v[120:123], a[240:243], v[224:227]
    ds_read_b64_tr_b16 v[92:93], v21 offset:16384
    s_lshl_b32 s58, s57, 7
    v_mfma_f32_16x16x32_bf16 v[228:231], v[120:123], a[244:247], v[228:231]
    buffer_load_dwordx4 v14, s[32:35], s65 offen offset:2048 lds
    v_mfma_f32_16x16x32_bf16 v[232:235], v[120:123], a[248:251], v[232:235]
    ds_read_b64_tr_b16 v[94:95], v21 offset:17408
    s_add_u32 s4, s12, s58
    v_mfma_f32_16x16x32_bf16 v[236:239], v[120:123], a[252:255], v[236:239]
    ds_read_b128 v[24:27], v23 offset:0
    s_add_u32 s5, s4, 458752
    v_mfma_f32_16x16x32_bf16 v[240:243], v[124:127], a[240:243], v[240:243]
    ds_read_b128 v[28:31], v23 offset:1024
    s_and_b32 s58, s53, 3
    v_mfma_f32_16x16x32_bf16 v[244:247], v[124:127], a[244:247], v[244:247]
    buffer_load_dwordx4 v15, s[32:35], s65 offen offset:3072 lds
    v_mfma_f32_16x16x32_bf16 v[248:251], v[124:127], a[248:251], v[248:251]
    s_add_u32 s65, s65, 128
    s_lshl_b32 s58, s58, 2
    s_lshr_b32 s1, 0x0, s58
    v_mfma_f32_16x16x32_bf16 v[252:255], v[124:127], a[252:255], v[252:255]
    s_and_b32 s1, s1, 7
    s_lshl_b32 s58, s1, 16
    s_add_u32 s12, s4, s58
    s_waitcnt lgkmcnt(12)
    v_mfma_f32_16x16x32_bf16 v[128:131], v[64:67], a[224:227], v[128:131]
    s_add_u32 m0, s66, 0
    ds_read_b64_tr_b16 v[96:97], v18 offset:8192
    v_mfma_f32_16x16x32_bf16 v[132:135], v[64:67], a[228:231], v[132:135]
    buffer_load_dwordx4 v4, s[36:39], s64 offen offset:0 lds
    v_mfma_f32_16x16x32_bf16 v[136:139], v[64:67], a[232:235], v[136:139]
    v_add_u32 v16, 0xc000, v16
    ds_read_b64_tr_b16 v[98:99], v18 offset:9216
    v_mfma_f32_16x16x32_bf16 v[140:143], v[64:67], a[236:239], v[140:143]
    ds_read_b128 a[240:243], v17 offset:0
    s_waitcnt lgkmcnt(3)
    v_mfma_f32_16x16x32_bf16 v[144:147], v[68:71], a[224:227], v[144:147]
    ds_read_b128 a[244:247], v17 offset:2048
    v_add_f32 v48, v48, v24
    v_mfma_f32_16x16x32_bf16 v[148:151], v[68:71], a[228:231], v[148:151]
    buffer_load_dwordx4 v5, s[36:39], s64 offen offset:1024 lds
    v_mfma_f32_16x16x32_bf16 v[152:155], v[68:71], a[232:235], v[152:155]
    ds_read_b128 a[248:251], v17 offset:4096
    v_add_f32 v49, v49, v25
    v_mfma_f32_16x16x32_bf16 v[156:159], v[68:71], a[236:239], v[156:159]
    ds_read_b128 a[252:255], v17 offset:6144
    v_add_u32 v17, 0xc000, v17
    v_mfma_f32_16x16x32_bf16 v[160:163], v[72:75], a[224:227], v[160:163]
    ds_read_b64_tr_b16 v[100:101], v18 offset:24576
    v_add_f32 v50, v50, v26
    v_mfma_f32_16x16x32_bf16 v[164:167], v[72:75], a[228:231], v[164:167]
    buffer_load_dwordx4 v6, s[36:39], s64 offen offset:2048 lds
    v_mfma_f32_16x16x32_bf16 v[168:171], v[72:75], a[232:235], v[168:171]
    ds_read_b64_tr_b16 v[102:103], v18 offset:25600
    v_add_u32 v18, 0xc000, v18
    v_mfma_f32_16x16x32_bf16 v[172:175], v[72:75], a[236:239], v[172:175]
    ds_read_b64_tr_b16 v[104:105], v19 offset:8192
    v_add_f32 v51, v51, v27
    v_mfma_f32_16x16x32_bf16 v[176:179], v[76:79], a[224:227], v[176:179]
    ds_read_b64_tr_b16 v[106:107], v19 offset:9216
    v_add_f32 v52, v52, v28
    v_mfma_f32_16x16x32_bf16 v[180:183], v[76:79], a[228:231], v[180:183]
    buffer_load_dwordx4 v7, s[36:39], s64 offen offset:3072 lds
    v_mfma_f32_16x16x32_bf16 v[184:187], v[76:79], a[232:235], v[184:187]
    ds_read_b64_tr_b16 v[108:109], v19 offset:24576
    v_add_f32 v53, v53, v29
    v_mfma_f32_16x16x32_bf16 v[188:191], v[76:79], a[236:239], v[188:191]
L_pg0:
    s_cbranch_execz L_pg4
    s_nop 0
    ds_read_b64_tr_b16 v[110:111], v19 offset:25600
    v_add_u32 v19, 0xc000, v19
    v_mfma_f32_16x16x32_bf16 v[192:195], v[80:83], a[224:227], v[192:195]
    s_add_u32 m0, s66, 4096
    ds_read_b64_tr_b16 v[112:113], v20 offset:8192
    v_mfma_f32_16x16x32_bf16 v[196:199], v[80:83], a[228:231], v[196:199]
    buffer_load_dwordx4 v8, s[36:39], s64 offen offset:0 lds
    v_mfma_f32_16x16x32_bf16 v[200:203], v[80:83], a[232:235], v[200:203]
    ds_read_b64_tr_b16 v[114:115], v20 offset:9216
    v_add_f32 v54, v54, v30
    v_mfma_f32_16x16x32_bf16 v[204:207], v[80:83], a[236:239], v[204:207]
    ds_read_b64_tr_b16 v[116:117], v20 offset:24576
    v_add_f32 v55, v55, v31
    v_mfma_f32_16x16x32_bf16 v[208:211], v[84:87], a[224:227], v[208:211]
    ds_read_b64_tr_b16 v[118:119], v20 offset:25600
    v_add_u32 v20, 0xc000, v20
    v_mfma_f32_16x16x32_bf16 v[212:215], v[84:87], a[228:231], v[212:215]
    buffer_load_dwordx4 v9, s[36:39], s64 offen offset:1024 lds
    v_mfma_f32_16x16x32_bf16 v[216:219], v[84:87], a[232:235], v[216:219]
    ds_read_b64_tr_b16 v[120:121], v21 offset:8192
    v_mfma_f32_16x16x32_bf16 v[220:223], v[84:87], a[236:239], v[220:223]
    ds_read_b64_tr_b16 v[122:123], v21 offset:9216
    v_mfma_f32_16x16x32_bf16 v[224:227], v[88:91], a[224:227], v[224:227]
    ds_read_b64_tr_b16 v[124:125], v21 offset:24576
    v_mfma_f32_16x16x32_bf16 v[228:231], v[88:91], a[228:231], v[228:231]
    buffer_load_dwordx4 v10, s[36:39], s64 offen offset:2048 lds
    v_mfma_f32_16x16x32_bf16 v[232:235], v[88:91], a[232:235], v[232:235]
    ds_read_b64_tr_b16 v[126:127], v21 offset:25600
    v_add_u32 v21, 0xc000, v21
    v_mfma_f32_16x16x32_bf16 v[236:239], v[88:91], a[236:239], v[236:239]
    ds_read_b128 v[24:27], v23 offset:2048
    v_mfma_f32_16x16x32_bf16 v[240:243], v[92:95], a[224:227], v[240:243]
    ds_read_b128 v[28:31], v23 offset:3072
    v_mfma_f32_16x16x32_bf16 v[244:247], v[92:95], a[228:231], v[244:247]
    buffer_load_dwordx4 v11, s[36:39], s64 offen offset:3072 lds
    v_mfma_f32_16x16x32_bf16 v[248:251], v[92:95], a[232:235], v[248:251]
    s_add_u32 s64, s64, 229376
    v_mfma_f32_16x16x32_bf16 v[252:255], v[92:95], a[236:239], v[252:255]
    s_waitcnt vmcnt(12) lgkmcnt(0)
    s_barrier
    v_mfma_f32_16x16x32_bf16 v[128:131], v[96:99], a[240:243], v[128:131]
    s_add_u32 m0, s67, 81920
    ds_read_b64_tr_b16 v[64:65], v18 offset:0
    v_mfma_f32_16x16x32_bf16 v[132:135], v[96:99], a[244:247], v[132:135]
    buffer_load_dwordx4 v12, s[32:35], s65 offen offset:0 lds
    v_mfma_f32_16x16x32_bf16 v[136:139], v[96:99], a[248:251], v[136:139]
    ds_read_b64_tr_b16 v[66:67], v18 offset:1024
    v_add_f32 v56, v56, v24
    v_mfma_f32_16x16x32_bf16 v[140:143], v[96:99], a[252:255], v[140:143]
    ds_read_b128 a[224:227], v16 offset:0
    v_add_f32 v57, v57, v25
    v_mfma_f32_16x16x32_bf16 v[144:147], v[100:103], a[240:243], v[144:147]
    ds_read_b128 a[228:231], v16 offset:2048
    v_add_f32 v58, v58, v26
    v_mfma_f32_16x16x32_bf16 v[148:151], v[100:103], a[244:247], v[148:151]
    buffer_load_dwordx4 v13, s[32:35], s65 offen offset:1024 lds
    v_mfma_f32_16x16x32_bf16 v[152:155], v[100:103], a[248:251], v[152:155]
    ds_read_b128 a[232:235], v16 offset:4096
    v_add_f32 v59, v59, v27
    v_mfma_f32_16x16x32_bf16 v[156:159], v[100:103], a[252:255], v[156:159]
    ds_read_b128 a[236:239], v16 offset:6144
    v_add_f32 v60, v60, v28
    v_mfma_f32_16x16x32_bf16 v[160:163], v[104:107], a[240:243], v[160:163]
    s_add_u32 m0, s13, 147456
    ds_read_b64_tr_b16 v[68:69], v18 offset:16384
    v_mfma_f32_16x16x32_bf16 v[164:167], v[104:107], a[244:247], v[164:167]
    buffer_load_dwordx4 v34, s[44:47], s12 offen offset:0 lds
    v_mfma_f32_16x16x32_bf16 v[168:171], v[104:107], a[248:251], v[168:171]
    ds_read_b64_tr_b16 v[70:71], v18 offset:17408
    v_add_f32 v61, v61, v29
    v_mfma_f32_16x16x32_bf16 v[172:175], v[104:107], a[252:255], v[172:175]
    ds_read_b64_tr_b16 v[72:73], v19 offset:0
    v_add_f32 v62, v62, v30
    v_mfma_f32_16x16x32_bf16 v[176:179], v[108:111], a[240:243], v[176:179]
    ds_read_b64_tr_b16 v[74:75], v19 offset:1024
    v_add_f32 v63, v63, v31
    v_mfma_f32_16x16x32_bf16 v[180:183], v[108:111], a[244:247], v[180:183]
    buffer_load_dwordx4 v35, s[44:47], s12 offen offset:1024 lds
    v_mfma_f32_16x16x32_bf16 v[184:187], v[108:111], a[248:251], v[184:187]
    ds_read_b64_tr_b16 v[76:77], v19 offset:16384
    s_sub_u32 s6, 0, s77
    v_mfma_f32_16x16x32_bf16 v[188:191], v[108:111], a[252:255], v[188:191]
    ds_read_b64_tr_b16 v[78:79], v19 offset:17408
    s_sub_u32 s7, 0, s77
    v_mfma_f32_16x16x32_bf16 v[192:195], v[112:115], a[240:243], v[192:195]
    s_add_u32 m0, s67, 81920
    ds_read_b64_tr_b16 v[80:81], v20 offset:0
    v_mfma_f32_16x16x32_bf16 v[196:199], v[112:115], a[244:247], v[196:199]
    buffer_load_dwordx4 v14, s[32:35], s65 offen offset:2048 lds
    v_mfma_f32_16x16x32_bf16 v[200:203], v[112:115], a[248:251], v[200:203]
    ds_read_b64_tr_b16 v[82:83], v20 offset:1024
    s_and_b32 s8, s6, 0x55555555
    v_mfma_f32_16x16x32_bf16 v[204:207], v[112:115], a[252:255], v[204:207]
    ds_read_b64_tr_b16 v[84:85], v20 offset:16384
    s_and_b32 s9, s6, 0x55555555
    v_mfma_f32_16x16x32_bf16 v[208:211], v[116:119], a[240:243], v[208:211]
    ds_read_b64_tr_b16 v[86:87], v20 offset:17408
    s_or_b32 s10, s6, 0x55555555
    v_mfma_f32_16x16x32_bf16 v[212:215], v[116:119], a[244:247], v[212:215]
    buffer_load_dwordx4 v15, s[32:35], s65 offen offset:3072 lds
    v_mfma_f32_16x16x32_bf16 v[216:219], v[116:119], a[248:251], v[216:219]
    s_add_u32 s65, s65, 128
    ds_read_b64_tr_b16 v[88:89], v21 offset:0
    v_mfma_f32_16x16x32_bf16 v[220:223], v[116:119], a[252:255], v[220:223]
    ds_read_b64_tr_b16 v[90:91], v21 offset:1024
    s_or_b32 s11, s6, 0x55555555
    v_mfma_f32_16x16x32_bf16 v[224:227], v[120:123], a[240:243], v[224:227]
    s_add_u32 m0, s66, 49152
    ds_read_b64_tr_b16 v[92:93], v21 offset:16384
    v_mfma_f32_16x16x32_bf16 v[228:231], v[120:123], a[244:247], v[228:231]
    buffer_load_dwordx4 v4, s[36:39], s64 offen offset:0 lds
    v_mfma_f32_16x16x32_bf16 v[232:235], v[120:123], a[248:251], v[232:235]
    ds_read_b64_tr_b16 v[94:95], v21 offset:17408
    s_and_b32 s58, s6, 0x80000000
    v_mfma_f32_16x16x32_bf16 v[236:239], v[120:123], a[252:255], v[236:239]
    s_mov_b32 s59, 0
    v_cvt_pk_bf16_f32 v32, v48, 0
    v_cndmask_b32 v32, v47, v32, s[58:59]
    v_mfma_f32_16x16x32_bf16 v[240:243], v[124:127], a[240:243], v[240:243]
    v_cndmask_b32 v48, v48, v49, s[6:7]
    v_cndmask_b32 v49, v49, v50, s[6:7]
    v_mfma_f32_16x16x32_bf16 v[244:247], v[124:127], a[244:247], v[244:247]
    buffer_load_dwordx4 v5, s[36:39], s64 offen offset:1024 lds
    v_mfma_f32_16x16x32_bf16 v[248:251], v[124:127], a[248:251], v[248:251]
    v_cndmask_b32 v50, v50, v51, s[6:7]
    v_cndmask_b32 v51, v51, v52, s[6:7]
    v_mfma_f32_16x16x32_bf16 v[252:255], v[124:127], a[252:255], v[252:255]
    v_cndmask_b32 v52, v52, v53, s[6:7]
    v_cndmask_b32 v53, v53, v54, s[6:7]
    s_waitcnt lgkmcnt(10)
    v_mfma_f32_16x16x32_bf16 v[128:131], v[64:67], a[224:227], v[128:131]
    ds_read_b64_tr_b16 v[96:97], v18 offset:8192
    v_add_u32 v16, 0xfffe8000, v16
    v_mfma_f32_16x16x32_bf16 v[132:135], v[64:67], a[228:231], v[132:135]
    buffer_load_dwordx4 v6, s[36:39], s64 offen offset:2048 lds
    v_mfma_f32_16x16x32_bf16 v[136:139], v[64:67], a[232:235], v[136:139]
    ds_read_b64_tr_b16 v[98:99], v18 offset:9216
    v_cndmask_b32 v54, v54, v55, s[6:7]
    v_mfma_f32_16x16x32_bf16 v[140:143], v[64:67], a[236:239], v[140:143]
    ds_read_b128 a[240:243], v17 offset:0
    v_cndmask_b32 v55, v55, v56, s[6:7]
    v_mfma_f32_16x16x32_bf16 v[144:147], v[68:71], a[224:227], v[144:147]
    ds_read_b128 a[244:247], v17 offset:2048
    v_and_b32 v22, 31, v1
    v_mfma_f32_16x16x32_bf16 v[148:151], v[68:71], a[228:231], v[148:151]
    buffer_load_dwordx4 v7, s[36:39], s64 offen offset:3072 lds
    v_mfma_f32_16x16x32_bf16 v[152:155], v[68:71], a[232:235], v[152:155]
    ds_read_b128 a[248:251], v17 offset:4096
    v_lshrrev_b32 v23, 5, v1
    v_mfma_f32_16x16x32_bf16 v[156:159], v[68:71], a[236:239], v[156:159]
    ds_read_b128 a[252:255], v17 offset:6144
    v_add_u32 v17, 0xfffe8000, v17
    v_mfma_f32_16x16x32_bf16 v[160:163], v[72:75], a[224:227], v[160:163]
    s_add_u32 m0, s13, 147456
    ds_read_b64_tr_b16 v[100:101], v18 offset:24576
    v_mfma_f32_16x16x32_bf16 v[164:167], v[72:75], a[228:231], v[164:167]
    buffer_load_dwordx4 v36, s[44:47], s12 offen offset:2048 lds
    v_mfma_f32_16x16x32_bf16 v[168:171], v[72:75], a[232:235], v[168:171]
    ds_read_b64_tr_b16 v[102:103], v18 offset:25600
    v_add_u32 v18, 0xfffe8000, v18
    v_mfma_f32_16x16x32_bf16 v[172:175], v[72:75], a[236:239], v[172:175]
    ds_read_b64_tr_b16 v[104:105], v19 offset:8192
    v_xor_b32 v23, 1, v23
    s_waitcnt lgkmcnt(13)
    v_mfma_f32_16x16x32_bf16 v[176:179], v[76:79], a[224:227], v[176:179]
    ds_read_b64_tr_b16 v[106:107], v19 offset:9216
    v_lshlrev_b32 v22, 4, v22
    v_mfma_f32_16x16x32_bf16 v[180:183], v[76:79], a[228:231], v[180:183]
    buffer_load_dwordx4 v37, s[44:47], s12 offen offset:3072 lds
    v_mfma_f32_16x16x32_bf16 v[184:187], v[76:79], a[232:235], v[184:187]
    s_add_u32 s12, s12, 32768
    ds_read_b64_tr_b16 v[108:109], v19 offset:24576
    v_mfma_f32_16x16x32_bf16 v[188:191], v[76:79], a[236:239], v[188:191]
    ds_read_b64_tr_b16 v[110:111], v19 offset:25600
    v_add_u32 v19, 0xfffe8000, v19
    v_mfma_f32_16x16x32_bf16 v[192:195], v[80:83], a[224:227], v[192:195]
    s_add_u32 m0, s66, 53248
    ds_read_b64_tr_b16 v[112:113], v20 offset:8192
    v_mfma_f32_16x16x32_bf16 v[196:199], v[80:83], a[228:231], v[196:199]
    buffer_load_dwordx4 v8, s[36:39], s64 offen offset:0 lds
    v_mfma_f32_16x16x32_bf16 v[200:203], v[80:83], a[232:235], v[200:203]
    ds_read_b64_tr_b16 v[114:115], v20 offset:9216
    s_mul_i32 s60, s3, 5184
    v_mfma_f32_16x16x32_bf16 v[204:207], v[80:83], a[236:239], v[204:207]
    ds_read_b64_tr_b16 v[116:117], v20 offset:24576
    s_add_u32 s60, s60, 65536
    v_mfma_f32_16x16x32_bf16 v[208:211], v[84:87], a[224:227], v[208:211]
    ds_read_b64_tr_b16 v[118:119], v20 offset:25600
    v_add_u32 v20, 0xfffe8000, v20
    v_mfma_f32_16x16x32_bf16 v[212:215], v[84:87], a[228:231], v[212:215]
    buffer_load_dwordx4 v9, s[36:39], s64 offen offset:1024 lds
    v_mfma_f32_16x16x32_bf16 v[216:219], v[84:87], a[232:235], v[216:219]
    ds_read_b64_tr_b16 v[120:121], v21 offset:8192
    v_add_u32 v22, s60, v22
    v_mfma_f32_16x16x32_bf16 v[220:223], v[84:87], a[236:239], v[220:223]
    ds_read_b64_tr_b16 v[122:123], v21 offset:9216
    v_lshlrev_b32 v23, 9, v23
    s_waitcnt lgkmcnt(15)
    v_mfma_f32_16x16x32_bf16 v[224:227], v[88:91], a[224:227], v[224:227]
    ds_read_b64_tr_b16 v[124:125], v21 offset:24576
    v_add_u32 v22, v22, v23
    v_mfma_f32_16x16x32_bf16 v[228:231], v[88:91], a[228:231], v[228:231]
    buffer_load_dwordx4 v10, s[36:39], s64 offen offset:2048 lds
    v_mfma_f32_16x16x32_bf16 v[232:235], v[88:91], a[232:235], v[232:235]
    ds_read_b64_tr_b16 v[126:127], v21 offset:25600
    v_add_u32 v21, 0xfffe8000, v21
    v_mfma_f32_16x16x32_bf16 v[236:239], v[88:91], a[236:239], v[236:239]
    s_waitcnt vmcnt(11)
    ds_read_b64_tr_b16 a[0:1], v42 offset:49152
    v_add_u32 v23, v22, v23
    v_mfma_f32_16x16x32_bf16 v[240:243], v[92:95], a[224:227], v[240:243]
    ds_read_b64_tr_b16 a[4:5], v43 offset:49152
    s_add_u32 s60, s60, 4220
    v_mfma_f32_16x16x32_bf16 v[244:247], v[92:95], a[228:231], v[244:247]
    buffer_load_dwordx4 v11, s[36:39], s64 offen offset:3072 lds
    v_mfma_f32_16x16x32_bf16 v[248:251], v[92:95], a[232:235], v[248:251]
    s_add_u32 s64, s64, 229376
    ds_read_b64_tr_b16 a[8:9], v44 offset:49152
    v_mfma_f32_16x16x32_bf16 v[252:255], v[92:95], a[236:239], v[252:255]
    ds_read_b64_tr_b16 a[12:13], v45 offset:49152
    v_sub_u32 v33, s60, v46
    s_waitcnt lgkmcnt(4)
    s_barrier
    v_mfma_f32_16x16x32_bf16 v[128:131], v[96:99], a[240:243], v[128:131]
    s_add_u32 m0, s67, 131072
    ds_read_b64_tr_b16 v[64:65], v18 offset:0
    v_mfma_f32_16x16x32_bf16 v[132:135], v[96:99], a[244:247], v[132:135]
    buffer_load_dwordx4 v12, s[32:35], s65 offen offset:0 lds
    v_mfma_f32_16x16x32_bf16 v[136:139], v[96:99], a[248:251], v[136:139]
    ds_read_b64_tr_b16 v[66:67], v18 offset:1024
    v_cvt_pk_bf16_f32 v24, v55, v54
    v_mfma_f32_16x16x32_bf16 v[140:143], v[96:99], a[252:255], v[140:143]
    ds_read_b128 a[224:227], v16 offset:0
    v_cvt_pk_bf16_f32 v25, v53, v52
    v_mfma_f32_16x16x32_bf16 v[144:147], v[100:103], a[240:243], v[144:147]
    ds_read_b128 a[228:231], v16 offset:2048
    v_cvt_pk_bf16_f32 v26, v51, v50
    v_mfma_f32_16x16x32_bf16 v[148:151], v[100:103], a[244:247], v[148:151]
    buffer_load_dwordx4 v13, s[32:35], s65 offen offset:1024 lds
    v_mfma_f32_16x16x32_bf16 v[152:155], v[100:103], a[248:251], v[152:155]
    s_waitcnt lgkmcnt(4)
    ds_read_b128 a[232:235], v16 offset:4096
    v_mfma_f32_16x16x32_bf16 v[156:159], v[100:103], a[252:255], v[156:159]
    ds_read_b128 a[236:239], v16 offset:6144
    v_cvt_pk_bf16_f32 v27, v49, v48
    v_mfma_f32_16x16x32_bf16 v[160:163], v[104:107], a[240:243], v[160:163]
    s_add_u32 m0, s13, 147456
    ds_read_b64_tr_b16 v[68:69], v18 offset:16384
    v_mfma_f32_16x16x32_bf16 v[164:167], v[104:107], a[244:247], v[164:167]
    buffer_load_dwordx4 v34, s[44:47], s12 offen offset:0 lds
    v_mfma_f32_16x16x32_bf16 v[168:171], v[104:107], a[248:251], v[168:171]
    ds_read_b64_tr_b16 v[70:71], v18 offset:17408
    v_cndmask_b32 v48, v57, v58, s[6:7]
    v_mfma_f32_16x16x32_bf16 v[172:175], v[104:107], a[252:255], v[172:175]
    ds_read_b64_tr_b16 v[72:73], v19 offset:0
    v_cndmask_b32 v49, v58, v59, s[6:7]
    v_mfma_f32_16x16x32_bf16 v[176:179], v[108:111], a[240:243], v[176:179]
    ds_read_b64_tr_b16 v[74:75], v19 offset:1024
    v_cvt_pk_bf16_f32 v28, v59, v59
    v_mfma_f32_16x16x32_bf16 v[180:183], v[108:111], a[244:247], v[180:183]
    buffer_load_dwordx4 v35, s[44:47], s12 offen offset:1024 lds
    v_mfma_f32_16x16x32_bf16 v[184:187], v[108:111], a[248:251], v[184:187]
    ds_read_b64_tr_b16 v[76:77], v19 offset:16384
    v_cvt_pk_bf16_f32 v29, v49, v58
    v_mfma_f32_16x16x32_bf16 v[188:191], v[108:111], a[252:255], v[188:191]
    ds_read_b64_tr_b16 v[78:79], v19 offset:17408
    v_cvt_pk_bf16_f32 v30, v58, v48
    v_mfma_f32_16x16x32_bf16 v[192:195], v[112:115], a[240:243], v[192:195]
    s_add_u32 m0, s67, 131072
    ds_read_b64_tr_b16 v[80:81], v20 offset:0
    v_mfma_f32_16x16x32_bf16 v[196:199], v[112:115], a[244:247], v[196:199]
    buffer_load_dwordx4 v14, s[32:35], s65 offen offset:2048 lds
    v_mfma_f32_16x16x32_bf16 v[200:203], v[112:115], a[248:251], v[200:203]
    ds_read_b64_tr_b16 v[82:83], v20 offset:1024
    v_cvt_pk_bf16_f32 v31, v57, v57
    v_mfma_f32_16x16x32_bf16 v[204:207], v[112:115], a[252:255], v[204:207]
    ds_read_b64_tr_b16 v[84:85], v20 offset:16384
    v_cndmask_b32 v50, v60, v61, s[8:9]
    v_mfma_f32_16x16x32_bf16 v[208:211], v[116:119], a[240:243], v[208:211]
    ds_read_b64_tr_b16 v[86:87], v20 offset:17408
    v_cndmask_b32 v51, v60, v61, s[10:11]
    v_mfma_f32_16x16x32_bf16 v[212:215], v[116:119], a[244:247], v[212:215]
    buffer_load_dwordx4 v15, s[32:35], s65 offen offset:3072 lds
    v_mfma_f32_16x16x32_bf16 v[216:219], v[116:119], a[248:251], v[216:219]
    s_add_u32 s65, s65, 128
    ds_read_b64_tr_b16 v[88:89], v21 offset:0
    v_mfma_f32_16x16x32_bf16 v[220:223], v[116:119], a[252:255], v[220:223]
    ds_read_b64_tr_b16 v[90:91], v21 offset:1024
    v_cvt_pk_bf16_f32 v52, v61, v61
    v_mfma_f32_16x16x32_bf16 v[224:227], v[120:123], a[240:243], v[224:227]
    s_add_u32 m0, s66, 98304
    ds_read_b64_tr_b16 v[92:93], v21 offset:16384
    v_mfma_f32_16x16x32_bf16 v[228:231], v[120:123], a[244:247], v[228:231]
    buffer_load_dwordx4 v4, s[36:39], s64 offen offset:0 lds
    v_mfma_f32_16x16x32_bf16 v[232:235], v[120:123], a[248:251], v[232:235]
    ds_read_b64_tr_b16 v[94:95], v21 offset:17408
    v_cvt_pk_bf16_f32 v53, v61, v51
    v_mfma_f32_16x16x32_bf16 v[236:239], v[120:123], a[252:255], v[236:239]
    s_waitcnt vmcnt(11)
    ds_read_b64_tr_b16 a[2:3], v42 offset:51200
    v_cvt_pk_bf16_f32 v54, v50, v60
    v_mfma_f32_16x16x32_bf16 v[240:243], v[124:127], a[240:243], v[240:243]
    ds_read_b64_tr_b16 a[6:7], v43 offset:51200
    v_cvt_pk_bf16_f32 v55, v60, v60
    v_mfma_f32_16x16x32_bf16 v[244:247], v[124:127], a[244:247], v[244:247]
    buffer_load_dwordx4 v5, s[36:39], s64 offen offset:1024 lds
    v_mfma_f32_16x16x32_bf16 v[248:251], v[124:127], a[248:251], v[248:251]
    ds_read_b64_tr_b16 a[10:11], v44 offset:51200
    v_cndmask_b32 v50, v62, v63, s[8:9]
    v_mfma_f32_16x16x32_bf16 v[252:255], v[124:127], a[252:255], v[252:255]
    ds_read_b64_tr_b16 a[14:15], v45 offset:51200
    v_cndmask_b32 v51, v62, v63, s[10:11]
    s_waitcnt lgkmcnt(14)
    v_mfma_f32_16x16x32_bf16 v[128:131], v[64:67], a[224:227], v[128:131]
    ds_read_b64_tr_b16 v[96:97], v18 offset:8192
    v_add_u32 v16, 0xc000, v16
    v_mfma_f32_16x16x32_bf16 v[132:135], v[64:67], a[228:231], v[132:135]
    buffer_load_dwordx4 v6, s[36:39], s64 offen offset:2048 lds
    v_mfma_f32_16x16x32_bf16 v[136:139], v[64:67], a[232:235], v[136:139]
    ds_read_b64_tr_b16 v[98:99], v18 offset:9216
    v_cvt_pk_bf16_f32 v56, v63, v63
    v_mfma_f32_16x16x32_bf16 v[140:143], v[64:67], a[236:239], v[140:143]
    ds_read_b128 a[240:243], v17 offset:0
    v_cvt_pk_bf16_f32 v57, v63, v51
    v_mfma_f32_16x16x32_bf16 v[144:147], v[68:71], a[224:227], v[144:147]
    ds_read_b128 a[244:247], v17 offset:2048
    v_cvt_pk_bf16_f32 v58, v50, v62
    v_mfma_f32_16x16x32_bf16 v[148:151], v[68:71], a[228:231], v[148:151]
    buffer_load_dwordx4 v7, s[36:39], s64 offen offset:3072 lds
    v_mfma_f32_16x16x32_bf16 v[152:155], v[68:71], a[232:235], v[152:155]
    s_waitcnt lgkmcnt(4)
    ds_read_b128 a[248:251], v17 offset:4096
    v_mfma_f32_16x16x32_bf16 v[156:159], v[68:71], a[236:239], v[156:159]
    ds_read_b128 a[252:255], v17 offset:6144
    v_add_u32 v17, 0xc000, v17
    v_mfma_f32_16x16x32_bf16 v[160:163], v[72:75], a[224:227], v[160:163]
    s_add_u32 m0, s13, 147456
    ds_read_b64_tr_b16 v[100:101], v18 offset:24576
    v_mfma_f32_16x16x32_bf16 v[164:167], v[72:75], a[228:231], v[164:167]
    buffer_load_dwordx4 v36, s[44:47], s12 offen offset:2048 lds
    v_mfma_f32_16x16x32_bf16 v[168:171], v[72:75], a[232:235], v[168:171]
    ds_read_b64_tr_b16 v[102:103], v18 offset:25600
    v_add_u32 v18, 0xc000, v18
    v_mfma_f32_16x16x32_bf16 v[172:175], v[72:75], a[236:239], v[172:175]
    ds_read_b64_tr_b16 v[104:105], v19 offset:8192
    v_cvt_pk_bf16_f32 v59, v62, v62
    v_mfma_f32_16x16x32_bf16 v[176:179], v[76:79], a[224:227], v[176:179]
    ds_read_b64_tr_b16 v[106:107], v19 offset:9216
    s_mul_i32 s60, s76, 4608
    v_mfma_f32_16x16x32_bf16 v[180:183], v[76:79], a[228:231], v[180:183]
    buffer_load_dwordx4 v37, s[44:47], s12 offen offset:3072 lds
    v_mfma_f32_16x16x32_bf16 v[184:187], v[76:79], a[232:235], v[184:187]
    s_add_u32 s12, s12, 32768
    s_cmp_eq_u32 s12, s5
    s_cselect_b32 s12, s4, s12
    v_mfma_f32_16x16x32_bf16 v[188:191], v[76:79], a[236:239], v[188:191]
    ds_read_b64_tr_b16 v[108:109], v19 offset:24576
    s_lshl_b32 s61, s77, 8
    v_mfma_f32_16x16x32_bf16 v[192:195], v[80:83], a[224:227], v[192:195]
    s_add_u32 m0, s66, 102400
    ds_read_b64_tr_b16 v[110:111], v19 offset:25600
    v_mfma_f32_16x16x32_bf16 v[196:199], v[80:83], a[228:231], v[196:199]
    buffer_load_dwordx4 v8, s[36:39], s64 offen offset:0 lds
    v_mfma_f32_16x16x32_bf16 v[200:203], v[80:83], a[232:235], v[200:203]
    v_add_u32 v19, 0xc000, v19
    ds_read_b64_tr_b16 v[112:113], v20 offset:8192
    v_mfma_f32_16x16x32_bf16 v[204:207], v[80:83], a[236:239], v[204:207]
    ds_read_b64_tr_b16 v[114:115], v20 offset:9216
    s_add_u32 s60, s60, s61
    v_mfma_f32_16x16x32_bf16 v[208:211], v[84:87], a[224:227], v[208:211]
    ds_read_b64_tr_b16 v[116:117], v20 offset:24576
    s_add_u32 s60, s60, 86272
    v_mfma_f32_16x16x32_bf16 v[212:215], v[84:87], a[228:231], v[212:215]
    buffer_load_dwordx4 v9, s[36:39], s64 offen offset:1024 lds
    v_mfma_f32_16x16x32_bf16 v[216:219], v[84:87], a[232:235], v[216:219]
    ds_read_b64_tr_b16 v[118:119], v20 offset:25600
    v_add_u32 v20, 0xc000, v20
    v_mfma_f32_16x16x32_bf16 v[220:223], v[84:87], a[236:239], v[220:223]
    ds_read_b64_tr_b16 v[120:121], v21 offset:8192
    v_add_u32 v48, s60, v46
    v_mfma_f32_16x16x32_bf16 v[224:227], v[88:91], a[224:227], v[224:227]
    ds_read_b64_tr_b16 v[122:123], v21 offset:9216
    s_lshl_b32 s59, s54, 1
    v_mfma_f32_16x16x32_bf16 v[228:231], v[88:91], a[228:231], v[228:231]
    buffer_load_dwordx4 v10, s[36:39], s64 offen offset:2048 lds
    v_mfma_f32_16x16x32_bf16 v[232:235], v[88:91], a[232:235], v[232:235]
    ds_read_b64_tr_b16 v[124:125], v21 offset:24576
    s_add_u32 s58, s77, s59
    v_mfma_f32_16x16x32_bf16 v[236:239], v[88:91], a[236:239], v[236:239]
    ds_read_b64_tr_b16 v[126:127], v21 offset:25600
    v_add_u32 v21, 0xc000, v21
    v_mfma_f32_16x16x32_bf16 v[240:243], v[92:95], a[224:227], v[240:243]
    s_waitcnt vmcnt(11)
    ds_read_b64_tr_b16 a[16:17], v42 offset:49152
    s_lshl_b32 s60, s55, 1
    v_mfma_f32_16x16x32_bf16 v[244:247], v[92:95], a[228:231], v[244:247]
    buffer_load_dwordx4 v11, s[36:39], s64 offen offset:3072 lds
    v_mfma_f32_16x16x32_bf16 v[248:251], v[92:95], a[232:235], v[248:251]
    s_add_u32 s64, s64, 229376
    ds_read_b64_tr_b16 a[20:21], v43 offset:49152
    v_mfma_f32_16x16x32_bf16 v[252:255], v[92:95], a[236:239], v[252:255]
    ds_read_b64_tr_b16 a[24:25], v44 offset:49152
    s_add_u32 s59, s76, s60
    ds_read_b64_tr_b16 a[28:29], v45 offset:49152
    s_waitcnt lgkmcnt(4)
    s_barrier
    v_mfma_f32_16x16x32_bf16 v[128:131], v[96:99], a[240:243], v[128:131]
    s_add_u32 m0, s67, 32768
    ds_read_b64_tr_b16 v[64:65], v18 offset:0
    v_mfma_f32_16x16x32_bf16 v[132:135], v[96:99], a[244:247], v[132:135]
    buffer_load_dwordx4 v12, s[32:35], s65 offen offset:0 lds
    v_mfma_f32_16x16x32_bf16 v[136:139], v[96:99], a[248:251], v[136:139]
    ds_read_b64_tr_b16 v[66:67], v18 offset:1024
    s_mul_i32 s14, s58, 28
    v_mfma_f32_16x16x32_bf16 v[140:143], v[96:99], a[252:255], v[140:143]
    ds_read_b128 a[224:227], v16 offset:0
    s_add_u32 s14, s14, s59
    v_mfma_f32_16x16x32_bf16 v[144:147], v[100:103], a[240:243], v[144:147]
    ds_read_b128 a[228:231], v16 offset:2048
    s_lshl_b32 s14, s14, 13
    v_mfma_f32_16x16x32_bf16 v[148:151], v[100:103], a[244:247], v[148:151]
    buffer_load_dwordx4 v13, s[32:35], s65 offen offset:1024 lds
    v_mfma_f32_16x16x32_bf16 v[152:155], v[100:103], a[248:251], v[152:155]
    s_waitcnt lgkmcnt(4)
    ds_read_b128 a[232:235], v16 offset:4096
    v_mfma_f32_16x16x32_bf16 v[156:159], v[100:103], a[252:255], v[156:159]
    ds_read_b128 a[236:239], v16 offset:6144
    s_add_u32 s14, s14, 6291456
    v_mfma_f32_16x16x32_bf16 v[160:163], v[104:107], a[240:243], v[160:163]
    s_add_u32 m0, s13, 147456
    ds_read_b64_tr_b16 v[68:69], v18 offset:16384
    v_mfma_f32_16x16x32_bf16 v[164:167], v[104:107], a[244:247], v[164:167]
    buffer_load_dwordx4 v34, s[44:47], s12 offen offset:0 lds
    v_mfma_f32_16x16x32_bf16 v[168:171], v[104:107], a[248:251], v[168:171]
    ds_read_b64_tr_b16 v[70:71], v18 offset:17408
    s_add_u32 s15, s14, 4096
    v_mfma_f32_16x16x32_bf16 v[172:175], v[104:107], a[252:255], v[172:175]
    ds_read_b64_tr_b16 v[72:73], v19 offset:0
    s_lshl_b32 s16, s58, 5
    v_mfma_f32_16x16x32_bf16 v[176:179], v[108:111], a[240:243], v[176:179]
    ds_read_b64_tr_b16 v[74:75], v19 offset:1024
    s_add_u32 s16, s16, s59
    v_mfma_f32_16x16x32_bf16 v[180:183], v[108:111], a[244:247], v[180:183]
    buffer_load_dwordx4 v35, s[44:47], s12 offen offset:1024 lds
    v_mfma_f32_16x16x32_bf16 v[184:187], v[108:111], a[248:251], v[184:187]
    ds_read_b64_tr_b16 v[76:77], v19 offset:16384
    s_lshl_b32 s16, s16, 7
    v_mfma_f32_16x16x32_bf16 v[188:191], v[108:111], a[252:255], v[188:191]
    ds_read_b64_tr_b16 v[78:79], v19 offset:17408
    s_add_u32 s16, s16, 262144
    v_mfma_f32_16x16x32_bf16 v[192:195], v[112:115], a[240:243], v[192:195]
    s_add_u32 m0, s67, 32768
    ds_read_b64_tr_b16 v[80:81], v20 offset:0
    v_mfma_f32_16x16x32_bf16 v[196:199], v[112:115], a[244:247], v[196:199]
    buffer_load_dwordx4 v14, s[32:35], s65 offen offset:2048 lds
    v_mfma_f32_16x16x32_bf16 v[200:203], v[112:115], a[248:251], v[200:203]
    ds_read_b64_tr_b16 v[82:83], v20 offset:1024
    s_mul_i32 s58, s2, 8448
    v_mfma_f32_16x16x32_bf16 v[204:207], v[112:115], a[252:255], v[204:207]
    ds_read_b64_tr_b16 v[84:85], v20 offset:16384
    s_mul_i32 s59, s76, 128
    v_mfma_f32_16x16x32_bf16 v[208:211], v[116:119], a[240:243], v[208:211]
    ds_read_b64_tr_b16 v[86:87], v20 offset:17408
    s_add_u32 s58, s58, s59
    v_mfma_f32_16x16x32_bf16 v[212:215], v[116:119], a[244:247], v[212:215]
    buffer_load_dwordx4 v15, s[32:35], s65 offen offset:3072 lds
    v_mfma_f32_16x16x32_bf16 v[216:219], v[116:119], a[248:251], v[216:219]
    s_add_u32 s65, s65, 128
    ds_read_b64_tr_b16 v[88:89], v21 offset:0
    v_mfma_f32_16x16x32_bf16 v[220:223], v[116:119], a[252:255], v[220:223]
    ds_read_b64_tr_b16 v[90:91], v21 offset:1024
    s_lshl_b32 s59, s3, 11
    v_mfma_f32_16x16x32_bf16 v[224:227], v[120:123], a[240:243], v[224:227]
    s_add_u32 m0, s66, 0
    ds_read_b64_tr_b16 v[92:93], v21 offset:16384
    v_mfma_f32_16x16x32_bf16 v[228:231], v[120:123], a[244:247], v[228:231]
    buffer_load_dwordx4 v4, s[36:39], s64 offen offset:0 lds
    v_mfma_f32_16x16x32_bf16 v[232:235], v[120:123], a[248:251], v[232:235]
    ds_read_b64_tr_b16 v[94:95], v21 offset:17408
    s_add_u32 s58, s58, s59
    v_mfma_f32_16x16x32_bf16 v[236:239], v[120:123], a[252:255], v[236:239]
    s_waitcnt vmcnt(11)
    ds_read_b64_tr_b16 a[18:19], v42 offset:51200
    s_add_u32 s20, s58, 1048576
    v_mfma_f32_16x16x32_bf16 v[240:243], v[124:127], a[240:243], v[240:243]
    ds_read_b64_tr_b16 a[22:23], v43 offset:51200
    s_add_u32 s23, s58, 3407872
    v_mfma_f32_16x16x32_bf16 v[244:247], v[124:127], a[244:247], v[244:247]
    buffer_load_dwordx4 v5, s[36:39], s64 offen offset:1024 lds
    v_mfma_f32_16x16x32_bf16 v[248:251], v[124:127], a[248:251], v[248:251]
    ds_read_b64_tr_b16 a[26:27], v44 offset:51200
    s_lshl_b32 s60, s76, 9
    v_mfma_f32_16x16x32_bf16 v[252:255], v[124:127], a[252:255], v[252:255]
    ds_read_b64_tr_b16 a[30:31], v45 offset:51200
    s_add_u32 s21, s59, s60
    s_waitcnt lgkmcnt(14)
    v_mfma_f32_16x16x32_bf16 v[128:131], v[64:67], a[224:227], v[128:131]
    ds_read_b64_tr_b16 v[96:97], v18 offset:8192
    v_add_u32 v16, 0xc000, v16
    v_mfma_f32_16x16x32_bf16 v[132:135], v[64:67], a[228:231], v[132:135]
    buffer_load_dwordx4 v6, s[36:39], s64 offen offset:2048 lds
    v_mfma_f32_16x16x32_bf16 v[136:139], v[64:67], a[232:235], v[136:139]
    ds_read_b64_tr_b16 v[98:99], v18 offset:9216
    s_and_b32 s22, s53, 3
    v_mfma_f32_16x16x32_bf16 v[140:143], v[64:67], a[236:239], v[140:143]
    ds_read_b128 a[240:243], v17 offset:0
    s_lshl_b32 s22, s22, 12
    v_mfma_f32_16x16x32_bf16 v[144:147], v[68:71], a[224:227], v[144:147]
    ds_read_b128 a[244:247], v17 offset:2048
    s_add_u32 s22, s22, 425984
    v_mfma_f32_16x16x32_bf16 v[148:151], v[68:71], a[228:231], v[148:151]
    buffer_load_dwordx4 v7, s[36:39], s64 offen offset:3072 lds
    v_mfma_f32_16x16x32_bf16 v[152:155], v[68:71], a[232:235], v[152:155]
    s_waitcnt lgkmcnt(4)
    ds_read_b128 a[248:251], v17 offset:4096
    v_mfma_f32_16x16x32_bf16 v[156:159], v[68:71], a[236:239], v[156:159]
    ds_read_b128 a[252:255], v17 offset:6144
    v_add_u32 v17, 0xc000, v17
    v_mfma_f32_16x16x32_bf16 v[160:163], v[72:75], a[224:227], v[160:163]
    s_add_u32 m0, s13, 147456
    ds_read_b64_tr_b16 v[100:101], v18 offset:24576
    v_mfma_f32_16x16x32_bf16 v[164:167], v[72:75], a[228:231], v[164:167]
    buffer_load_dwordx4 v36, s[44:47], s12 offen offset:2048 lds
    v_mfma_f32_16x16x32_bf16 v[168:171], v[72:75], a[232:235], v[168:171]
    ds_read_b64_tr_b16 v[102:103], v18 offset:25600
    v_add_u32 v18, 0xc000, v18
    v_mfma_f32_16x16x32_bf16 v[172:175], v[72:75], a[236:239], v[172:175]
    ds_read_b64_tr_b16 v[104:105], v19 offset:8192
    s_lshr_b32 s58, s2, 5
    v_mfma_f32_16x16x32_bf16 v[176:179], v[76:79], a[224:227], v[176:179]
    ds_read_b64_tr_b16 v[106:107], v19 offset:9216
    s_lshl_b32 s58, s58, 1
    v_mfma_f32_16x16x32_bf16 v[180:183], v[76:79], a[228:231], v[180:183]
    buffer_load_dwordx4 v37, s[44:47], s12 offen offset:3072 lds
    v_mfma_f32_16x16x32_bf16 v[184:187], v[76:79], a[232:235], v[184:187]
    s_add_u32 s12, s12, 32768
    ds_read_b64_tr_b16 v[108:109], v19 offset:24576
    v_mfma_f32_16x16x32_bf16 v[188:191], v[76:79], a[236:239], v[188:191]
    ds_read_b64_tr_b16 v[110:111], v19 offset:25600
    v_add_u32 v19, 0xc000, v19
    v_mfma_f32_16x16x32_bf16 v[192:195], v[80:83], a[224:227], v[192:195]
    s_add_u32 m0, s66, 4096
    ds_read_b64_tr_b16 v[112:113], v20 offset:8192
    v_mfma_f32_16x16x32_bf16 v[196:199], v[80:83], a[228:231], v[196:199]
L_pg1:
    s_cbranch_execz L_pg5
    s_nop 0
    buffer_load_dwordx4 v8, s[36:39], s64 offen offset:0 lds
    v_mfma_f32_16x16x32_bf16 v[200:203], v[80:83], a[232:235], v[200:203]
    ds_read_b64_tr_b16 v[114:115], v20 offset:9216
    s_add_u32 s58, s58, s77
    v_mfma_f32_16x16x32_bf16 v[204:207], v[80:83], a[236:239], v[204:207]
    ds_read_b64_tr_b16 v[116:117], v20 offset:24576
    s_lshl_b32 s58, s58, 4
    v_mfma_f32_16x16x32_bf16 v[208:211], v[84:87], a[224:227], v[208:211]
    ds_read_b64_tr_b16 v[118:119], v20 offset:25600
    v_add_u32 v20, 0xc000, v20
    v_mfma_f32_16x16x32_bf16 v[212:215], v[84:87], a[228:231], v[212:215]
    buffer_load_dwordx4 v9, s[36:39], s64 offen offset:1024 lds
    v_mfma_f32_16x16x32_bf16 v[216:219], v[84:87], a[232:235], v[216:219]
    ds_read_b64_tr_b16 v[120:121], v21 offset:8192
    s_bfe_u32 s59, s2, 0x40001
    v_mfma_f32_16x16x32_bf16 v[220:223], v[84:87], a[236:239], v[220:223]
    ds_read_b64_tr_b16 v[122:123], v21 offset:9216
    s_add_u32 s58, s58, s59
    v_mfma_f32_16x16x32_bf16 v[224:227], v[88:91], a[224:227], v[224:227]
    ds_read_b64_tr_b16 v[124:125], v21 offset:24576
    s_lshl_b32 s58, s58, 7
    v_mfma_f32_16x16x32_bf16 v[228:231], v[88:91], a[228:231], v[228:231]
    buffer_load_dwordx4 v10, s[36:39], s64 offen offset:2048 lds
    v_mfma_f32_16x16x32_bf16 v[232:235], v[88:91], a[232:235], v[232:235]
    ds_read_b64_tr_b16 v[126:127], v21 offset:25600
    v_add_u32 v21, 0xc000, v21
    v_mfma_f32_16x16x32_bf16 v[236:239], v[88:91], a[236:239], v[236:239]
    s_waitcnt vmcnt(11)
    ds_read_b64_tr_b16 a[32:33], v42 offset:49152
    s_and_b32 s59, s2, 1
    v_mfma_f32_16x16x32_bf16 v[240:243], v[92:95], a[224:227], v[240:243]
    ds_read_b64_tr_b16 a[36:37], v43 offset:49152
    s_lshl_b32 s59, s59, 1
    v_mfma_f32_16x16x32_bf16 v[244:247], v[92:95], a[228:231], v[244:247]
    buffer_load_dwordx4 v11, s[36:39], s64 offen offset:3072 lds
    v_mfma_f32_16x16x32_bf16 v[248:251], v[92:95], a[232:235], v[248:251]
    s_add_u32 s64, s64, 229376
    ds_read_b64_tr_b16 a[40:41], v44 offset:49152
    v_mfma_f32_16x16x32_bf16 v[252:255], v[92:95], a[236:239], v[252:255]
    ds_read_b64_tr_b16 a[44:45], v45 offset:49152
    s_add_u32 s59, s59, s76
    s_waitcnt lgkmcnt(4)
    s_barrier
    v_mfma_f32_16x16x32_bf16 v[128:131], v[96:99], a[240:243], v[128:131]
    s_add_u32 m0, s67, 81920
    ds_read_b64_tr_b16 v[64:65], v18 offset:0
    v_mfma_f32_16x16x32_bf16 v[132:135], v[96:99], a[244:247], v[132:135]
    buffer_load_dwordx4 v12, s[32:35], s65 offen offset:0 lds
    v_mfma_f32_16x16x32_bf16 v[136:139], v[96:99], a[248:251], v[136:139]
    ds_read_b64_tr_b16 v[66:67], v18 offset:1024
    s_lshl_b32 s59, s59, 2
    v_mfma_f32_16x16x32_bf16 v[140:143], v[96:99], a[252:255], v[140:143]
    ds_read_b128 a[224:227], v16 offset:0
    s_add_u32 s24, s58, s59
    v_mfma_f32_16x16x32_bf16 v[144:147], v[100:103], a[240:243], v[144:147]
    ds_read_b128 a[228:231], v16 offset:2048
    s_add_u32 s24, s24, 393216
    v_mfma_f32_16x16x32_bf16 v[148:151], v[100:103], a[244:247], v[148:151]
    buffer_load_dwordx4 v13, s[32:35], s65 offen offset:1024 lds
    v_mfma_f32_16x16x32_bf16 v[152:155], v[100:103], a[248:251], v[152:155]
    s_waitcnt lgkmcnt(4)
    ds_read_b128 a[232:235], v16 offset:4096
    v_mfma_f32_16x16x32_bf16 v[156:159], v[100:103], a[252:255], v[156:159]
    ds_read_b128 a[236:239], v16 offset:6144
    v_mfma_f32_16x16x32_bf16 v[160:163], v[104:107], a[240:243], v[160:163]
    s_add_u32 m0, s13, 147456
    ds_read_b64_tr_b16 v[68:69], v18 offset:16384
    v_mfma_f32_16x16x32_bf16 v[164:167], v[104:107], a[244:247], v[164:167]
    buffer_load_dwordx4 v34, s[44:47], s12 offen offset:0 lds
    v_mfma_f32_16x16x32_bf16 v[168:171], v[104:107], a[248:251], v[168:171]
    ds_read_b64_tr_b16 v[70:71], v18 offset:17408
    v_mfma_f32_16x16x32_bf16 v[172:175], v[104:107], a[252:255], v[172:175]
    ds_read_b64_tr_b16 v[72:73], v19 offset:0
    v_mfma_f32_16x16x32_bf16 v[176:179], v[108:111], a[240:243], v[176:179]
    ds_read_b64_tr_b16 v[74:75], v19 offset:1024
    v_mfma_f32_16x16x32_bf16 v[180:183], v[108:111], a[244:247], v[180:183]
    buffer_load_dwordx4 v35, s[44:47], s12 offen offset:1024 lds
    v_mfma_f32_16x16x32_bf16 v[184:187], v[108:111], a[248:251], v[184:187]
    ds_read_b64_tr_b16 v[76:77], v19 offset:16384
    v_mfma_f32_16x16x32_bf16 v[188:191], v[108:111], a[252:255], v[188:191]
    ds_read_b64_tr_b16 v[78:79], v19 offset:17408
    v_mfma_f32_16x16x32_bf16 v[192:195], v[112:115], a[240:243], v[192:195]
    s_add_u32 m0, s67, 81920
    ds_read_b64_tr_b16 v[80:81], v20 offset:0
    v_mfma_f32_16x16x32_bf16 v[196:199], v[112:115], a[244:247], v[196:199]
    buffer_load_dwordx4 v14, s[32:35], s65 offen offset:2048 lds
    v_mfma_f32_16x16x32_bf16 v[200:203], v[112:115], a[248:251], v[200:203]
    ds_read_b64_tr_b16 v[82:83], v20 offset:1024
    v_mfma_f32_16x16x32_bf16 v[204:207], v[112:115], a[252:255], v[204:207]
    ds_read_b64_tr_b16 v[84:85], v20 offset:16384
    v_mfma_f32_16x16x32_bf16 v[208:211], v[116:119], a[240:243], v[208:211]
    ds_read_b64_tr_b16 v[86:87], v20 offset:17408
    v_mfma_f32_16x16x32_bf16 v[212:215], v[116:119], a[244:247], v[212:215]
    buffer_load_dwordx4 v15, s[32:35], s65 offen offset:3072 lds
    v_mfma_f32_16x16x32_bf16 v[216:219], v[116:119], a[248:251], v[216:219]
    s_add_u32 s65, s65, 128
    ds_read_b64_tr_b16 v[88:89], v21 offset:0
    v_mfma_f32_16x16x32_bf16 v[220:223], v[116:119], a[252:255], v[220:223]
    ds_read_b64_tr_b16 v[90:91], v21 offset:1024
    v_mfma_f32_16x16x32_bf16 v[224:227], v[120:123], a[240:243], v[224:227]
    s_add_u32 m0, s66, 49152
    ds_read_b64_tr_b16 v[92:93], v21 offset:16384
    v_mfma_f32_16x16x32_bf16 v[228:231], v[120:123], a[244:247], v[228:231]
    buffer_load_dwordx4 v4, s[36:39], s64 offen offset:0 lds
    v_mfma_f32_16x16x32_bf16 v[232:235], v[120:123], a[248:251], v[232:235]
    ds_read_b64_tr_b16 v[94:95], v21 offset:17408
    v_mfma_f32_16x16x32_bf16 v[236:239], v[120:123], a[252:255], v[236:239]
    s_waitcnt vmcnt(11)
    ds_read_b64_tr_b16 a[34:35], v42 offset:51200
    v_mfma_f32_16x16x32_bf16 v[240:243], v[124:127], a[240:243], v[240:243]
    ds_read_b64_tr_b16 a[38:39], v43 offset:51200
    v_mfma_f32_16x16x32_bf16 v[244:247], v[124:127], a[244:247], v[244:247]
    buffer_load_dwordx4 v5, s[36:39], s64 offen offset:1024 lds
    v_mfma_f32_16x16x32_bf16 v[248:251], v[124:127], a[248:251], v[248:251]
    ds_read_b64_tr_b16 a[42:43], v44 offset:51200
    v_mfma_f32_16x16x32_bf16 v[252:255], v[124:127], a[252:255], v[252:255]
    ds_read_b64_tr_b16 a[46:47], v45 offset:51200
    s_waitcnt lgkmcnt(14)
    v_mfma_f32_16x16x32_bf16 v[128:131], v[64:67], a[224:227], v[128:131]
    ds_read_b64_tr_b16 v[96:97], v18 offset:8192
    v_add_u32 v16, 0xfffe8000, v16
    v_mfma_f32_16x16x32_bf16 v[132:135], v[64:67], a[228:231], v[132:135]
    buffer_load_dwordx4 v6, s[36:39], s64 offen offset:2048 lds
    v_mfma_f32_16x16x32_bf16 v[136:139], v[64:67], a[232:235], v[136:139]
    ds_read_b64_tr_b16 v[98:99], v18 offset:9216
    v_mfma_f32_16x16x32_bf16 v[140:143], v[64:67], a[236:239], v[140:143]
    ds_read_b128 a[240:243], v17 offset:0
    v_mfma_f32_16x16x32_bf16 v[144:147], v[68:71], a[224:227], v[144:147]
    ds_read_b128 a[244:247], v17 offset:2048
    v_mfma_f32_16x16x32_bf16 v[148:151], v[68:71], a[228:231], v[148:151]
    buffer_load_dwordx4 v7, s[36:39], s64 offen offset:3072 lds
    v_mfma_f32_16x16x32_bf16 v[152:155], v[68:71], a[232:235], v[152:155]
    s_waitcnt lgkmcnt(4)
    ds_read_b128 a[248:251], v17 offset:4096
    v_mfma_f32_16x16x32_bf16 v[156:159], v[68:71], a[236:239], v[156:159]
    ds_read_b128 a[252:255], v17 offset:6144
    v_add_u32 v17, 0xfffe8000, v17
    v_mfma_f32_16x16x32_bf16 v[160:163], v[72:75], a[224:227], v[160:163]
    s_add_u32 m0, s13, 147456
    ds_read_b64_tr_b16 v[100:101], v18 offset:24576
    v_mfma_f32_16x16x32_bf16 v[164:167], v[72:75], a[228:231], v[164:167]
    buffer_load_dwordx4 v36, s[44:47], s12 offen offset:2048 lds
    v_mfma_f32_16x16x32_bf16 v[168:171], v[72:75], a[232:235], v[168:171]
    ds_read_b64_tr_b16 v[102:103], v18 offset:25600
    v_add_u32 v18, 0xfffe8000, v18
    v_mfma_f32_16x16x32_bf16 v[172:175], v[72:75], a[236:239], v[172:175]
    ds_read_b64_tr_b16 v[104:105], v19 offset:8192
    v_mfma_f32_16x16x32_bf16 v[176:179], v[76:79], a[224:227], v[176:179]
    ds_read_b64_tr_b16 v[106:107], v19 offset:9216
    v_mfma_f32_16x16x32_bf16 v[180:183], v[76:79], a[228:231], v[180:183]
    buffer_load_dwordx4 v37, s[44:47], s12 offen offset:3072 lds
    v_mfma_f32_16x16x32_bf16 v[184:187], v[76:79], a[232:235], v[184:187]
    s_add_u32 s12, s12, 32768
    s_cmp_eq_u32 s12, s5
    s_cselect_b32 s12, s4, s12
    v_mfma_f32_16x16x32_bf16 v[188:191], v[76:79], a[236:239], v[188:191]
    ds_read_b64_tr_b16 v[108:109], v19 offset:24576
    v_mfma_f32_16x16x32_bf16 v[192:195], v[80:83], a[224:227], v[192:195]
    s_add_u32 m0, s66, 53248
    ds_read_b64_tr_b16 v[110:111], v19 offset:25600
    v_mfma_f32_16x16x32_bf16 v[196:199], v[80:83], a[228:231], v[196:199]
    buffer_load_dwordx4 v8, s[36:39], s64 offen offset:0 lds
    v_mfma_f32_16x16x32_bf16 v[200:203], v[80:83], a[232:235], v[200:203]
    v_add_u32 v19, 0xfffe8000, v19
    ds_read_b64_tr_b16 v[112:113], v20 offset:8192
    v_mfma_f32_16x16x32_bf16 v[204:207], v[80:83], a[236:239], v[204:207]
    ds_read_b64_tr_b16 v[114:115], v20 offset:9216
    v_mfma_f32_16x16x32_bf16 v[208:211], v[84:87], a[224:227], v[208:211]
    ds_read_b64_tr_b16 v[116:117], v20 offset:24576
    v_mfma_f32_16x16x32_bf16 v[212:215], v[84:87], a[228:231], v[212:215]
    buffer_load_dwordx4 v9, s[36:39], s64 offen offset:1024 lds
    v_mfma_f32_16x16x32_bf16 v[216:219], v[84:87], a[232:235], v[216:219]
    ds_read_b64_tr_b16 v[118:119], v20 offset:25600
    v_add_u32 v20, 0xfffe8000, v20
    v_mfma_f32_16x16x32_bf16 v[220:223], v[84:87], a[236:239], v[220:223]
    ds_read_b64_tr_b16 v[120:121], v21 offset:8192
    v_mfma_f32_16x16x32_bf16 v[224:227], v[88:91], a[224:227], v[224:227]
    ds_read_b64_tr_b16 v[122:123], v21 offset:9216
    v_mfma_f32_16x16x32_bf16 v[228:231], v[88:91], a[228:231], v[228:231]
    buffer_load_dwordx4 v10, s[36:39], s64 offen offset:2048 lds
    v_mfma_f32_16x16x32_bf16 v[232:235], v[88:91], a[232:235], v[232:235]
    ds_read_b64_tr_b16 v[124:125], v21 offset:24576
    v_mfma_f32_16x16x32_bf16 v[236:239], v[88:91], a[236:239], v[236:239]
    ds_read_b64_tr_b16 v[126:127], v21 offset:25600
    v_add_u32 v21, 0xfffe8000, v21
    v_mfma_f32_16x16x32_bf16 v[240:243], v[92:95], a[224:227], v[240:243]
    s_waitcnt vmcnt(11)
    ds_read_b64_tr_b16 a[48:49], v42 offset:49152
    v_mfma_f32_16x16x32_bf16 v[244:247], v[92:95], a[228:231], v[244:247]
    buffer_load_dwordx4 v11, s[36:39], s64 offen offset:3072 lds
    v_mfma_f32_16x16x32_bf16 v[248:251], v[92:95], a[232:235], v[248:251]
    s_add_u32 s64, s64, 229376
    ds_read_b64_tr_b16 a[52:53], v43 offset:49152
    v_mfma_f32_16x16x32_bf16 v[252:255], v[92:95], a[236:239], v[252:255]
    ds_read_b64_tr_b16 a[56:57], v44 offset:49152
    ds_read_b64_tr_b16 a[60:61], v45 offset:49152
    s_waitcnt lgkmcnt(4)
    s_barrier
    v_mfma_f32_16x16x32_bf16 v[128:131], v[96:99], a[240:243], v[128:131]
    s_lshl_b32 s63, s53, 2
    s_add_u32 s63, s63, s3
    s_lshl_b32 s63, s63, 8
    v_mfma_f32_16x16x32_bf16 v[132:135], v[96:99], a[244:247], v[132:135]
    v_lshrrev_b32 v63, 5, v1
    v_lshl_add_u32 v63, v63, 7, s63
    v_mfma_f32_16x16x32_bf16 v[136:139], v[96:99], a[248:251], v[136:139]
    v_min_u32 v63, 0x3c00, v63
    ds_read_b64_tr_b16 v[64:65], v18 offset:0
    v_mfma_f32_16x16x32_bf16 v[140:143], v[96:99], a[252:255], v[140:143]
    s_getpc_b64 s[68:69]
    global_load_dword v0, v63, s[68:69]
    v_mfma_f32_16x16x32_bf16 v[144:147], v[100:103], a[240:243], v[144:147]
    ds_read_b64_tr_b16 v[66:67], v18 offset:1024
    v_and_b32 v60, 1, v1
    v_mfma_f32_16x16x32_bf16 v[148:151], v[100:103], a[244:247], v[148:151]
    ds_read_b128 a[224:227], v16 offset:0
    v_xor_b32 v60, 1, v60
    v_mfma_f32_16x16x32_bf16 v[152:155], v[100:103], a[248:251], v[152:155]
    s_add_u32 m0, s13, 98304
    ds_read_b128 a[228:231], v16 offset:2048
    v_mfma_f32_16x16x32_bf16 v[156:159], v[100:103], a[252:255], v[156:159]
    buffer_load_dwordx4 v34, s[44:47], s12 offen offset:0 lds
    v_mfma_f32_16x16x32_bf16 v[160:163], v[104:107], a[240:243], v[160:163]
    ds_read_b128 a[232:235], v16 offset:4096
    v_mul_u32_u24 v60, 5188, v60
    v_mfma_f32_16x16x32_bf16 v[164:167], v[104:107], a[244:247], v[164:167]
    ds_read_b128 a[236:239], v16 offset:6144
    v_lshrrev_b32 v61, 4, v1
    v_mfma_f32_16x16x32_bf16 v[168:171], v[104:107], a[248:251], v[168:171]
    ds_read_b64_tr_b16 v[68:69], v18 offset:16384
    v_lshl_add_u32 v60, v61, 4, v60
    v_mfma_f32_16x16x32_bf16 v[172:175], v[104:107], a[252:255], v[172:175]
    buffer_load_dwordx4 v35, s[44:47], s12 offen offset:1024 lds
    v_mfma_f32_16x16x32_bf16 v[176:179], v[108:111], a[240:243], v[176:179]
    ds_read_b64_tr_b16 v[70:71], v18 offset:17408
    v_bfe_u32 v62, v1, 1, 3
    v_mfma_f32_16x16x32_bf16 v[180:183], v[108:111], a[244:247], v[180:183]
    ds_read_b64_tr_b16 v[72:73], v19 offset:0
    v_lshlrev_b32 v62, 2, v62
    v_mfma_f32_16x16x32_bf16 v[184:187], v[108:111], a[248:251], v[184:187]
    ds_read_b64_tr_b16 v[74:75], v19 offset:1024
    v_sub_u32 v60, v60, v62
    v_mfma_f32_16x16x32_bf16 v[188:191], v[108:111], a[252:255], v[188:191]
    buffer_load_dwordx4 v36, s[44:47], s12 offen offset:2048 lds
    v_mfma_f32_16x16x32_bf16 v[192:195], v[112:115], a[240:243], v[192:195]
    ds_read_b64_tr_b16 v[76:77], v19 offset:16384
    s_mul_i32 s60, s76, 10368
    v_mfma_f32_16x16x32_bf16 v[196:199], v[112:115], a[244:247], v[196:199]
    ds_read_b64_tr_b16 v[78:79], v19 offset:17408
    s_lshl_b32 s61, s77, 8
    v_mfma_f32_16x16x32_bf16 v[200:203], v[112:115], a[248:251], v[200:203]
    ds_read_b64_tr_b16 v[80:81], v20 offset:0
    s_sub_u32 s60, s60, s61
    v_mfma_f32_16x16x32_bf16 v[204:207], v[112:115], a[252:255], v[204:207]
    buffer_load_dwordx4 v37, s[44:47], s12 offen offset:3072 lds
    v_mfma_f32_16x16x32_bf16 v[208:211], v[116:119], a[240:243], v[208:211]
    s_add_u32 s12, s12, 32768
    ds_read_b64_tr_b16 v[82:83], v20 offset:1024
    v_mfma_f32_16x16x32_bf16 v[212:215], v[116:119], a[244:247], v[212:215]
    ds_read_b64_tr_b16 v[84:85], v20 offset:16384
    v_add_u32 v60, s60, v60
    v_mfma_f32_16x16x32_bf16 v[216:219], v[116:119], a[248:251], v[216:219]
    s_add_u32 m0, s13, 114688
    ds_read_b64_tr_b16 v[86:87], v20 offset:17408
    v_mfma_f32_16x16x32_bf16 v[220:223], v[116:119], a[252:255], v[220:223]
    buffer_load_dwordx4 v34, s[44:47], s12 offen offset:0 lds
    v_mfma_f32_16x16x32_bf16 v[224:227], v[120:123], a[240:243], v[224:227]
    ds_read_b64_tr_b16 v[88:89], v21 offset:0
    v_add_u32 v4, 68892, v60
    v_mfma_f32_16x16x32_bf16 v[228:231], v[120:123], a[244:247], v[228:231]
    ds_read_b64_tr_b16 v[90:91], v21 offset:1024
    v_add_u32 v5, 67868, v60
    v_mfma_f32_16x16x32_bf16 v[232:235], v[120:123], a[248:251], v[232:235]
    ds_read_b64_tr_b16 v[92:93], v21 offset:16384
    v_add_u32 v6, 66844, v60
    v_mfma_f32_16x16x32_bf16 v[236:239], v[120:123], a[252:255], v[236:239]
    buffer_load_dwordx4 v35, s[44:47], s12 offen offset:1024 lds
    v_mfma_f32_16x16x32_bf16 v[240:243], v[124:127], a[240:243], v[240:243]
    ds_read_b64_tr_b16 v[94:95], v21 offset:17408
    v_add_u32 v7, 65820, v60
    v_mfma_f32_16x16x32_bf16 v[244:247], v[124:127], a[244:247], v[244:247]
    s_waitcnt vmcnt(11)
    ds_read_b64_tr_b16 a[50:51], v42 offset:51200
    v_and_b32 v60, 15, v1
    v_mfma_f32_16x16x32_bf16 v[248:251], v[124:127], a[248:251], v[248:251]
    ds_read_b64_tr_b16 a[54:55], v43 offset:51200
    v_lshlrev_b32 v60, 5, v60
    v_mfma_f32_16x16x32_bf16 v[252:255], v[124:127], a[252:255], v[252:255]
    buffer_load_dwordx4 v36, s[44:47], s12 offen offset:2048 lds
    ds_read_b64_tr_b16 a[58:59], v44 offset:51200
    ds_read_b64_tr_b16 a[62:63], v45 offset:51200
    s_waitcnt lgkmcnt(14)
    v_mfma_f32_16x16x32_bf16 v[128:131], v[64:67], a[224:227], v[128:131]
    ds_read_b64_tr_b16 v[96:97], v18 offset:8192
    v_add_u32 v16, 0xc000, v16
    v_mfma_f32_16x16x32_bf16 v[132:135], v[64:67], a[228:231], v[132:135]
    ds_read_b64_tr_b16 v[98:99], v18 offset:9216
    v_lshl_add_u32 v62, v61, 4, v60
    v_mfma_f32_16x16x32_bf16 v[136:139], v[64:67], a[232:235], v[136:139]
    ds_read_b128 a[240:243], v17 offset:0
    s_mul_i32 s60, s76, 4608
    v_mfma_f32_16x16x32_bf16 v[140:143], v[64:67], a[236:239], v[140:143]
    buffer_load_dwordx4 v37, s[44:47], s12 offen offset:3072 lds
    v_mfma_f32_16x16x32_bf16 v[144:147], v[68:71], a[224:227], v[144:147]
    s_add_u32 s12, s12, 32768
    s_cmp_eq_u32 s12, s5
    s_cselect_b32 s12, s4, s12
    v_mfma_f32_16x16x32_bf16 v[148:151], v[68:71], a[228:231], v[148:151]
    ds_read_b128 a[244:247], v17 offset:2048
    s_sub_u32 s62, s60, s61
    v_mfma_f32_16x16x32_bf16 v[152:155], v[68:71], a[232:235], v[152:155]
    s_add_u32 m0, s13, 131072
    ds_read_b128 a[248:251], v17 offset:4096
    v_mfma_f32_16x16x32_bf16 v[156:159], v[68:71], a[236:239], v[156:159]
    buffer_load_dwordx4 v34, s[44:47], s12 offen offset:0 lds
    v_mfma_f32_16x16x32_bf16 v[160:163], v[72:75], a[224:227], v[160:163]
    ds_read_b128 a[252:255], v17 offset:6144
    v_add_u32 v17, 0xc000, v17
    v_mfma_f32_16x16x32_bf16 v[164:167], v[72:75], a[228:231], v[164:167]
    ds_read_b64_tr_b16 v[100:101], v18 offset:24576
    s_add_u32 s62, s62, 86560
    v_mfma_f32_16x16x32_bf16 v[168:171], v[72:75], a[232:235], v[168:171]
    ds_read_b64_tr_b16 v[102:103], v18 offset:25600
    v_add_u32 v18, 0xc000, v18
    v_mfma_f32_16x16x32_bf16 v[172:175], v[72:75], a[236:239], v[172:175]
    buffer_load_dwordx4 v35, s[44:47], s12 offen offset:1024 lds
    s_waitcnt lgkmcnt(15)
    v_mfma_f32_16x16x32_bf16 v[176:179], v[76:79], a[224:227], v[176:179]
    ds_read_b64_tr_b16 v[104:105], v19 offset:8192
    v_add_u32 v8, s62, v62
    v_mfma_f32_16x16x32_bf16 v[180:183], v[76:79], a[228:231], v[180:183]
    ds_read_b64_tr_b16 v[106:107], v19 offset:9216
    v_lshl_add_u32 v14, v61, 3, v60
    v_mfma_f32_16x16x32_bf16 v[184:187], v[76:79], a[232:235], v[184:187]
    ds_read_b64_tr_b16 v[108:109], v19 offset:24576
    s_add_u32 s60, s21, 86784
    v_mfma_f32_16x16x32_bf16 v[188:191], v[76:79], a[236:239], v[188:191]
    buffer_load_dwordx4 v36, s[44:47], s12 offen offset:2048 lds
    v_mfma_f32_16x16x32_bf16 v[192:195], v[80:83], a[224:227], v[192:195]
    ds_read_b64_tr_b16 v[110:111], v19 offset:25600
    v_add_u32 v19, 0xc000, v19
    v_mfma_f32_16x16x32_bf16 v[196:199], v[80:83], a[228:231], v[196:199]
    ds_read_b64_tr_b16 v[112:113], v20 offset:8192
    v_add_u32 v11, s60, v14
    v_mfma_f32_16x16x32_bf16 v[200:203], v[80:83], a[232:235], v[200:203]
    ds_read_b64_tr_b16 v[114:115], v20 offset:9216
    s_add_u32 s62, s13, 131072
    v_mfma_f32_16x16x32_bf16 v[204:207], v[80:83], a[236:239], v[204:207]
    buffer_load_dwordx4 v37, s[44:47], s12 offen offset:3072 lds
    v_mfma_f32_16x16x32_bf16 v[208:211], v[84:87], a[224:227], v[208:211]
    s_add_u32 s12, s12, 32768
    ds_read_b64_tr_b16 v[116:117], v20 offset:24576
    v_mfma_f32_16x16x32_bf16 v[212:215], v[84:87], a[228:231], v[212:215]
    ds_read_b64_tr_b16 v[118:119], v20 offset:25600
    v_add_u32 v20, 0xc000, v20
    v_mfma_f32_16x16x32_bf16 v[216:219], v[84:87], a[232:235], v[216:219]
    s_add_u32 m0, s13, 147456
    ds_read_b64_tr_b16 v[120:121], v21 offset:8192
    v_mfma_f32_16x16x32_bf16 v[220:223], v[84:87], a[236:239], v[220:223]
    buffer_load_dwordx4 v34, s[44:47], s12 offen offset:0 lds
    s_waitcnt lgkmcnt(15)
    v_mfma_f32_16x16x32_bf16 v[224:227], v[88:91], a[224:227], v[224:227]
    ds_read_b64_tr_b16 v[122:123], v21 offset:9216
    v_add_u32 v9, s62, v2
    v_mfma_f32_16x16x32_bf16 v[228:231], v[88:91], a[228:231], v[228:231]
    ds_read_b64_tr_b16 v[124:125], v21 offset:24576
    v_xor_b32 v10, 4096, v9
    v_mfma_f32_16x16x32_bf16 v[232:235], v[88:91], a[232:235], v[232:235]
    ds_read_b64_tr_b16 v[126:127], v21 offset:25600
    v_add_u32 v21, 0xc000, v21
    v_mfma_f32_16x16x32_bf16 v[236:239], v[88:91], a[236:239], v[236:239]
    buffer_load_dwordx4 v35, s[44:47], s12 offen offset:1024 lds
    v_mfma_f32_16x16x32_bf16 v[240:243], v[92:95], a[224:227], v[240:243]
    s_waitcnt vmcnt(12)
    ds_read_b64_tr_b16 a[64:65], v42 offset:0
    v_mfma_f32_16x16x32_bf16 v[244:247], v[92:95], a[228:231], v[244:247]
    ds_read_b64_tr_b16 a[68:69], v43 offset:0
    v_mfma_f32_16x16x32_bf16 v[248:251], v[92:95], a[232:235], v[248:251]
    ds_read_b64_tr_b16 a[72:73], v44 offset:0
    v_mfma_f32_16x16x32_bf16 v[252:255], v[92:95], a[236:239], v[252:255]
    buffer_load_dwordx4 v36, s[44:47], s12 offen offset:2048 lds
    ds_read_b64_tr_b16 a[76:77], v45 offset:0
    s_waitcnt lgkmcnt(4)
    s_barrier
    v_mfma_f32_16x16x32_bf16 v[128:131], v[96:99], a[240:243], v[128:131]
    ds_read_b64_tr_b16 v[64:65], v18 offset:0
    v_mfma_f32_16x16x32_bf16 v[132:135], v[96:99], a[244:247], v[132:135]
    ds_read_b64_tr_b16 v[66:67], v18 offset:1024
    v_mfma_f32_16x16x32_bf16 v[136:139], v[96:99], a[248:251], v[136:139]
    ds_read_b128 a[224:227], v16 offset:0
    v_mfma_f32_16x16x32_bf16 v[140:143], v[96:99], a[252:255], v[140:143]
    buffer_load_dwordx4 v37, s[44:47], s12 offen offset:3072 lds
    v_mfma_f32_16x16x32_bf16 v[144:147], v[100:103], a[240:243], v[144:147]
    s_add_u32 s12, s12, 32768
    s_cmp_eq_u32 s12, s5
    s_cselect_b32 s12, s4, s12
    v_mfma_f32_16x16x32_bf16 v[148:151], v[100:103], a[244:247], v[148:151]
    ds_read_b128 a[228:231], v16 offset:2048
    v_mfma_f32_16x16x32_bf16 v[152:155], v[100:103], a[248:251], v[152:155]
    s_add_u32 m0, s13, 0
    ds_read_b128 a[232:235], v16 offset:4096
    v_mfma_f32_16x16x32_bf16 v[156:159], v[100:103], a[252:255], v[156:159]
    buffer_load_dwordx4 v34, s[44:47], s12 offen offset:0 lds
    v_mfma_f32_16x16x32_bf16 v[160:163], v[104:107], a[240:243], v[160:163]
    ds_read_b128 a[236:239], v16 offset:6144
    v_mfma_f32_16x16x32_bf16 v[164:167], v[104:107], a[244:247], v[164:167]
    ds_read_b64_tr_b16 v[68:69], v18 offset:16384
    v_mfma_f32_16x16x32_bf16 v[168:171], v[104:107], a[248:251], v[168:171]
    ds_read_b64_tr_b16 v[70:71], v18 offset:17408
    v_mfma_f32_16x16x32_bf16 v[172:175], v[104:107], a[252:255], v[172:175]
    buffer_load_dwordx4 v35, s[44:47], s12 offen offset:1024 lds
    v_mfma_f32_16x16x32_bf16 v[176:179], v[108:111], a[240:243], v[176:179]
    ds_read_b64_tr_b16 v[72:73], v19 offset:0
    v_mfma_f32_16x16x32_bf16 v[180:183], v[108:111], a[244:247], v[180:183]
    ds_read_b64_tr_b16 v[74:75], v19 offset:1024
    v_mfma_f32_16x16x32_bf16 v[184:187], v[108:111], a[248:251], v[184:187]
    ds_read_b64_tr_b16 v[76:77], v19 offset:16384
    v_mfma_f32_16x16x32_bf16 v[188:191], v[108:111], a[252:255], v[188:191]
    buffer_load_dwordx4 v36, s[44:47], s12 offen offset:2048 lds
    v_mfma_f32_16x16x32_bf16 v[192:195], v[112:115], a[240:243], v[192:195]
    ds_read_b64_tr_b16 v[78:79], v19 offset:17408
    v_mfma_f32_16x16x32_bf16 v[196:199], v[112:115], a[244:247], v[196:199]
    ds_read_b64_tr_b16 v[80:81], v20 offset:0
    v_mfma_f32_16x16x32_bf16 v[200:203], v[112:115], a[248:251], v[200:203]
    ds_read_b64_tr_b16 v[82:83], v20 offset:1024
    v_mfma_f32_16x16x32_bf16 v[204:207], v[112:115], a[252:255], v[204:207]
    buffer_load_dwordx4 v37, s[44:47], s12 offen offset:3072 lds
    v_mfma_f32_16x16x32_bf16 v[208:211], v[116:119], a[240:243], v[208:211]
    s_add_u32 s12, s12, 32768
    ds_read_b64_tr_b16 v[84:85], v20 offset:16384
    v_mfma_f32_16x16x32_bf16 v[212:215], v[116:119], a[244:247], v[212:215]
    ds_read_b64_tr_b16 v[86:87], v20 offset:17408
    v_mfma_f32_16x16x32_bf16 v[216:219], v[116:119], a[248:251], v[216:219]
    s_add_u32 m0, s13, 16384
    ds_read_b64_tr_b16 v[88:89], v21 offset:0
    v_mfma_f32_16x16x32_bf16 v[220:223], v[116:119], a[252:255], v[220:223]
    buffer_load_dwordx4 v34, s[44:47], s12 offen offset:0 lds
    v_mfma_f32_16x16x32_bf16 v[224:227], v[120:123], a[240:243], v[224:227]
    ds_read_b64_tr_b16 v[90:91], v21 offset:1024
    v_mfma_f32_16x16x32_bf16 v[228:231], v[120:123], a[244:247], v[228:231]
    ds_read_b64_tr_b16 v[92:93], v21 offset:16384
    v_mfma_f32_16x16x32_bf16 v[232:235], v[120:123], a[248:251], v[232:235]
    ds_read_b64_tr_b16 v[94:95], v21 offset:17408
    v_mfma_f32_16x16x32_bf16 v[236:239], v[120:123], a[252:255], v[236:239]
    buffer_load_dwordx4 v35, s[44:47], s12 offen offset:1024 lds
    v_mfma_f32_16x16x32_bf16 v[240:243], v[124:127], a[240:243], v[240:243]
    s_waitcnt vmcnt(18)
    ds_read_b64_tr_b16 a[66:67], v42 offset:2048
    v_mfma_f32_16x16x32_bf16 v[244:247], v[124:127], a[244:247], v[244:247]
    ds_read_b64_tr_b16 a[70:71], v43 offset:2048
    v_mfma_f32_16x16x32_bf16 v[248:251], v[124:127], a[248:251], v[248:251]
    ds_read_b64_tr_b16 a[74:75], v44 offset:2048
    v_mfma_f32_16x16x32_bf16 v[252:255], v[124:127], a[252:255], v[252:255]
    buffer_load_dwordx4 v36, s[44:47], s12 offen offset:2048 lds
    ds_read_b64_tr_b16 a[78:79], v45 offset:2048
    s_waitcnt lgkmcnt(14)
    v_mfma_f32_16x16x32_bf16 v[128:131], v[64:67], a[224:227], v[128:131]
    ds_read_b64_tr_b16 v[96:97], v18 offset:8192
    v_mfma_f32_16x16x32_bf16 v[132:135], v[64:67], a[228:231], v[132:135]
    ds_read_b64_tr_b16 v[98:99], v18 offset:9216
    v_mfma_f32_16x16x32_bf16 v[136:139], v[64:67], a[232:235], v[136:139]
    ds_read_b128 a[240:243], v17 offset:0
    v_mfma_f32_16x16x32_bf16 v[140:143], v[64:67], a[236:239], v[140:143]
    buffer_load_dwordx4 v37, s[44:47], s12 offen offset:3072 lds
    v_mfma_f32_16x16x32_bf16 v[144:147], v[68:71], a[224:227], v[144:147]
    s_add_u32 s12, s12, 32768
    s_cmp_eq_u32 s12, s5
    s_cselect_b32 s12, s4, s12
    v_mfma_f32_16x16x32_bf16 v[148:151], v[68:71], a[228:231], v[148:151]
    ds_read_b128 a[244:247], v17 offset:2048
    v_mfma_f32_16x16x32_bf16 v[152:155], v[68:71], a[232:235], v[152:155]
    s_add_u32 m0, s13, 32768
    ds_read_b128 a[248:251], v17 offset:4096
    v_mfma_f32_16x16x32_bf16 v[156:159], v[68:71], a[236:239], v[156:159]
    buffer_load_dwordx4 v34, s[44:47], s12 offen offset:0 lds
    v_mfma_f32_16x16x32_bf16 v[160:163], v[72:75], a[224:227], v[160:163]
    ds_read_b128 a[252:255], v17 offset:6144
    v_mfma_f32_16x16x32_bf16 v[164:167], v[72:75], a[228:231], v[164:167]
    ds_read_b64_tr_b16 v[100:101], v18 offset:24576
    v_mfma_f32_16x16x32_bf16 v[168:171], v[72:75], a[232:235], v[168:171]
    ds_read_b64_tr_b16 v[102:103], v18 offset:25600
    v_mfma_f32_16x16x32_bf16 v[172:175], v[72:75], a[236:239], v[172:175]
    buffer_load_dwordx4 v35, s[44:47], s12 offen offset:1024 lds
    s_waitcnt lgkmcnt(15)
    v_mfma_f32_16x16x32_bf16 v[176:179], v[76:79], a[224:227], v[176:179]
    ds_read_b64_tr_b16 v[104:105], v19 offset:8192
    v_mfma_f32_16x16x32_bf16 v[180:183], v[76:79], a[228:231], v[180:183]
    ds_read_b64_tr_b16 v[106:107], v19 offset:9216
    v_mfma_f32_16x16x32_bf16 v[184:187], v[76:79], a[232:235], v[184:187]
    ds_read_b64_tr_b16 v[108:109], v19 offset:24576
    v_mfma_f32_16x16x32_bf16 v[188:191], v[76:79], a[236:239], v[188:191]
    buffer_load_dwordx4 v36, s[44:47], s12 offen offset:2048 lds
    v_mfma_f32_16x16x32_bf16 v[192:195], v[80:83], a[224:227], v[192:195]
    ds_read_b64_tr_b16 v[110:111], v19 offset:25600
    v_mfma_f32_16x16x32_bf16 v[196:199], v[80:83], a[228:231], v[196:199]
    ds_read_b64_tr_b16 v[112:113], v20 offset:8192
    v_mfma_f32_16x16x32_bf16 v[200:203], v[80:83], a[232:235], v[200:203]
    ds_read_b64_tr_b16 v[114:115], v20 offset:9216
    v_mfma_f32_16x16x32_bf16 v[204:207], v[80:83], a[236:239], v[204:207]
    buffer_load_dwordx4 v37, s[44:47], s12 offen offset:3072 lds
    v_mfma_f32_16x16x32_bf16 v[208:211], v[84:87], a[224:227], v[208:211]
    s_add_u32 s12, s12, 32768
    ds_read_b64_tr_b16 v[116:117], v20 offset:24576
    v_mfma_f32_16x16x32_bf16 v[212:215], v[84:87], a[228:231], v[212:215]
    ds_read_b64_tr_b16 v[118:119], v20 offset:25600
    v_mfma_f32_16x16x32_bf16 v[216:219], v[84:87], a[232:235], v[216:219]
    ds_read_b64_tr_b16 v[120:121], v21 offset:8192
    v_mfma_f32_16x16x32_bf16 v[220:223], v[84:87], a[236:239], v[220:223]
    ds_read_b64_tr_b16 v[122:123], v21 offset:9216
    s_waitcnt lgkmcnt(15)
    v_mfma_f32_16x16x32_bf16 v[224:227], v[88:91], a[224:227], v[224:227]
    ds_read_b64_tr_b16 v[124:125], v21 offset:24576
    v_mfma_f32_16x16x32_bf16 v[228:231], v[88:91], a[228:231], v[228:231]
    ds_read_b64_tr_b16 v[126:127], v21 offset:25600
    v_mfma_f32_16x16x32_bf16 v[232:235], v[88:91], a[232:235], v[232:235]
    s_waitcnt vmcnt(22)
    ds_read_b64_tr_b16 a[80:81], v42 offset:16384
    v_mfma_f32_16x16x32_bf16 v[236:239], v[88:91], a[236:239], v[236:239]
    ds_read_b64_tr_b16 a[84:85], v43 offset:16384
    v_mfma_f32_16x16x32_bf16 v[240:243], v[92:95], a[224:227], v[240:243]
    ds_read_b64_tr_b16 a[88:89], v44 offset:16384
    v_mfma_f32_16x16x32_bf16 v[244:247], v[92:95], a[228:231], v[244:247]
    ds_read_b64_tr_b16 a[92:93], v45 offset:16384
    v_mfma_f32_16x16x32_bf16 v[248:251], v[92:95], a[232:235], v[248:251]
    v_mfma_f32_16x16x32_bf16 v[252:255], v[92:95], a[236:239], v[252:255]
    s_waitcnt lgkmcnt(4)
    s_barrier
    v_mfma_f32_16x16x32_bf16 v[128:131], v[96:99], a[240:243], v[128:131]
    s_add_u32 m0, s13, 49152
    s_waitcnt vmcnt(20)
    ds_read_b64_tr_b16 a[82:83], v42 offset:18432
    v_mfma_f32_16x16x32_bf16 v[132:135], v[96:99], a[244:247], v[132:135]
    buffer_load_dwordx4 v34, s[44:47], s12 offen offset:0 lds
    v_mfma_f32_16x16x32_bf16 v[136:139], v[96:99], a[248:251], v[136:139]
    ds_read_b64_tr_b16 a[86:87], v43 offset:18432
    v_mfma_f32_16x16x32_bf16 v[140:143], v[96:99], a[252:255], v[140:143]
    ds_read_b64_tr_b16 a[90:91], v44 offset:18432
    v_mfma_f32_16x16x32_bf16 v[144:147], v[100:103], a[240:243], v[144:147]
    ds_read_b64_tr_b16 a[94:95], v45 offset:18432
    v_mfma_f32_16x16x32_bf16 v[148:151], v[100:103], a[244:247], v[148:151]
    buffer_load_dwordx4 v35, s[44:47], s12 offen offset:1024 lds
    v_mfma_f32_16x16x32_bf16 v[152:155], v[100:103], a[248:251], v[152:155]
L_pg2:
    s_cbranch_execz L_pg6
    s_nop 0
    s_waitcnt vmcnt(20)
    ds_read_b64_tr_b16 a[96:97], v42 offset:32768
    v_mfma_f32_16x16x32_bf16 v[156:159], v[100:103], a[252:255], v[156:159]
    ds_read_b64_tr_b16 a[100:101], v43 offset:32768
    v_mfma_f32_16x16x32_bf16 v[160:163], v[104:107], a[240:243], v[160:163]
    ds_read_b64_tr_b16 a[104:105], v44 offset:32768
    v_mfma_f32_16x16x32_bf16 v[164:167], v[104:107], a[244:247], v[164:167]
    buffer_load_dwordx4 v36, s[44:47], s12 offen offset:2048 lds
    v_mfma_f32_16x16x32_bf16 v[168:171], v[104:107], a[248:251], v[168:171]
    ds_read_b64_tr_b16 a[108:109], v45 offset:32768
    v_mfma_f32_16x16x32_bf16 v[172:175], v[104:107], a[252:255], v[172:175]
    s_waitcnt vmcnt(19)
    ds_read_b64_tr_b16 a[98:99], v42 offset:34816
    v_mfma_f32_16x16x32_bf16 v[176:179], v[108:111], a[240:243], v[176:179]
    ds_read_b64_tr_b16 a[102:103], v43 offset:34816
    v_mfma_f32_16x16x32_bf16 v[180:183], v[108:111], a[244:247], v[180:183]
    buffer_load_dwordx4 v37, s[44:47], s12 offen offset:3072 lds
    v_mfma_f32_16x16x32_bf16 v[184:187], v[108:111], a[248:251], v[184:187]
    s_add_u32 s12, s12, 32768
    s_cmp_eq_u32 s12, s5
    s_cselect_b32 s12, s4, s12
    v_mfma_f32_16x16x32_bf16 v[188:191], v[108:111], a[252:255], v[188:191]
    ds_read_b64_tr_b16 a[106:107], v44 offset:34816
    v_mfma_f32_16x16x32_bf16 v[192:195], v[112:115], a[240:243], v[192:195]
    ds_read_b64_tr_b16 a[110:111], v45 offset:34816
    v_mfma_f32_16x16x32_bf16 v[196:199], v[112:115], a[244:247], v[196:199]
    s_waitcnt vmcnt(18)
    ds_read_b64_tr_b16 a[112:113], v42 offset:49152
    v_mfma_f32_16x16x32_bf16 v[200:203], v[112:115], a[248:251], v[200:203]
    ds_read_b64_tr_b16 a[116:117], v43 offset:49152
    v_mfma_f32_16x16x32_bf16 v[204:207], v[112:115], a[252:255], v[204:207]
    ds_read_b64_tr_b16 a[120:121], v44 offset:49152
    v_mfma_f32_16x16x32_bf16 v[208:211], v[116:119], a[240:243], v[208:211]
    ds_read_b64_tr_b16 a[124:125], v45 offset:49152
    v_mfma_f32_16x16x32_bf16 v[212:215], v[116:119], a[244:247], v[212:215]
    s_waitcnt vmcnt(16)
    ds_read_b64_tr_b16 a[114:115], v42 offset:51200
    v_mfma_f32_16x16x32_bf16 v[216:219], v[116:119], a[248:251], v[216:219]
    ds_read_b64_tr_b16 a[118:119], v43 offset:51200
    v_mfma_f32_16x16x32_bf16 v[220:223], v[116:119], a[252:255], v[220:223]
    ds_read_b64_tr_b16 a[122:123], v44 offset:51200
    v_mfma_f32_16x16x32_bf16 v[224:227], v[120:123], a[240:243], v[224:227]
    v_and_b32 v12, 31, v1
    v_lshlrev_b32 v12, 7, v12
    v_mfma_f32_16x16x32_bf16 v[228:231], v[120:123], a[244:247], v[228:231]
    buffer_load_dword v13, v12, s[40:43], s22 offen sc1
    v_mfma_f32_16x16x32_bf16 v[232:235], v[120:123], a[248:251], v[232:235]
    ds_read_b64_tr_b16 a[126:127], v45 offset:51200
    v_mfma_f32_16x16x32_bf16 v[236:239], v[120:123], a[252:255], v[236:239]
    v_mfma_f32_16x16x32_bf16 v[240:243], v[124:127], a[240:243], v[240:243]
    v_mfma_f32_16x16x32_bf16 v[244:247], v[124:127], a[244:247], v[244:247]
    v_mfma_f32_16x16x32_bf16 v[248:251], v[124:127], a[248:251], v[248:251]
    v_mfma_f32_16x16x32_bf16 v[252:255], v[124:127], a[252:255], v[252:255]
L_ep:
    s_mov_b32 s68, 0xbfb8aa3b
    s_nop 4
    v_pk_mul_f32 v[96:97], v[128:129], s[68:69] op_sel_hi:[1,0]
    v_pk_mul_f32 v[98:99], v[130:131], s[68:69] op_sel_hi:[1,0]
    v_exp_f32 v96, v96
    v_exp_f32 v97, v97
    v_exp_f32 v98, v98
    v_exp_f32 v99, v99
    v_pk_mul_f32 v[128:129], v[128:129], v[144:145]
    v_pk_add_f32 v[96:97], v[96:97], 1.0 op_sel_hi:[1,0]
    v_pk_add_f32 v[98:99], v[98:99], 1.0 op_sel_hi:[1,0]
    v_rcp_f32 v96, v96
    v_rcp_f32 v97, v97
    v_rcp_f32 v98, v98
    v_rcp_f32_e64 v99, v99
    v_pk_mul_f32 v[130:131], v[130:131], v[146:147]
    v_pk_mul_f32 v[128:129], v[128:129], v[96:97]
    v_pk_mul_f32 v[130:131], v[130:131], v[98:99]
    v_cvt_pk_bf16_f32 v64, v128, v129
    v_cvt_pk_bf16_f32 v65, v130, v131
    v_pk_mul_f32 v[100:101], v[160:161], s[68:69] op_sel_hi:[1,0]
    v_pk_mul_f32 v[102:103], v[162:163], s[68:69] op_sel_hi:[1,0]
    v_exp_f32 v100, v100
    v_exp_f32 v101, v101
    v_exp_f32 v102, v102
    v_exp_f32 v103, v103
    v_pk_mul_f32 v[160:161], v[160:161], v[176:177]
    v_pk_add_f32 v[100:101], v[100:101], 1.0 op_sel_hi:[1,0]
    v_pk_add_f32 v[102:103], v[102:103], 1.0 op_sel_hi:[1,0]
    v_rcp_f32 v100, v100
    v_rcp_f32 v101, v101
    v_rcp_f32 v102, v102
    v_rcp_f32 v103, v103
    v_pk_mul_f32 v[162:163], v[162:163], v[178:179]
    v_pk_mul_f32 v[160:161], v[160:161], v[100:101]
    v_pk_mul_f32 v[162:163], v[162:163], v[102:103]
    v_cvt_pk_bf16_f32 v66, v160, v161
    v_cvt_pk_bf16_f32 v67, v162, v163
    buffer_store_dwordx4 v[64:67], v2, s[40:43], s14 offen offset:0 sc1
    v_pk_mul_f32 v[96:97], v[132:133], s[68:69] op_sel_hi:[1,0]
    v_pk_mul_f32 v[98:99], v[134:135], s[68:69] op_sel_hi:[1,0]
    v_exp_f32 v96, v96
    v_exp_f32 v97, v97
    v_exp_f32 v98, v98
    v_exp_f32 v99, v99
    v_pk_mul_f32 v[132:133], v[132:133], v[148:149]
    v_pk_add_f32 v[96:97], v[96:97], 1.0 op_sel_hi:[1,0]
    v_pk_add_f32 v[98:99], v[98:99], 1.0 op_sel_hi:[1,0]
    v_rcp_f32 v96, v96
    v_rcp_f32 v97, v97
    v_rcp_f32 v98, v98
    v_rcp_f32 v99, v99
    v_pk_mul_f32 v[134:135], v[134:135], v[150:151]
    v_pk_mul_f32 v[132:133], v[132:133], v[96:97]
    v_pk_mul_f32 v[134:135], v[134:135], v[98:99]
    v_cvt_pk_bf16_f32 v72, v132, v133
    v_cvt_pk_bf16_f32 v73, v134, v135
    v_pk_mul_f32 v[100:101], v[164:165], s[68:69] op_sel_hi:[1,0]
    v_pk_mul_f32 v[102:103], v[166:167], s[68:69] op_sel_hi:[1,0]
    v_exp_f32 v100, v100
    v_exp_f32 v101, v101
    v_exp_f32 v102, v102
    v_exp_f32 v103, v103
    v_pk_mul_f32 v[164:165], v[164:165], v[180:181]
    v_pk_add_f32 v[100:101], v[100:101], 1.0 op_sel_hi:[1,0]
    v_pk_add_f32 v[102:103], v[102:103], 1.0 op_sel_hi:[1,0]
    v_rcp_f32 v100, v100
    v_rcp_f32 v101, v101
    v_rcp_f32 v102, v102
    v_rcp_f32 v103, v103
    v_pk_mul_f32 v[166:167], v[166:167], v[182:183]
    v_pk_mul_f32 v[164:165], v[164:165], v[100:101]
    v_pk_mul_f32 v[166:167], v[166:167], v[102:103]
    v_cvt_pk_bf16_f32 v74, v164, v165
    v_cvt_pk_bf16_f32 v75, v166, v167
    buffer_store_dwordx4 v[72:75], v2, s[40:43], s14 offen offset:2048 sc1
    v_pk_mul_f32 v[96:97], v[136:137], s[68:69] op_sel_hi:[1,0]
    s_waitcnt vmcnt(2)
    v_pk_mul_f32 v[98:99], v[138:139], s[68:69] op_sel_hi:[1,0]
    v_exp_f32 v96, v96
    v_exp_f32_e64 v97, v97
    v_exp_f32 v98, v98
    v_exp_f32 v99, v99
    v_cmp_ne_u32 vcc, s19, v13
    v_pk_mul_f32 v[136:137], v[136:137], v[152:153]
    v_pk_add_f32 v[96:97], v[96:97], 1.0 op_sel_hi:[1,0]
    v_pk_add_f32 v[98:99], v[98:99], 1.0 op_sel_hi:[1,0]
    v_rcp_f32 v96, v96
    v_rcp_f32 v97, v97
    s_cbranch_vccnz L_spin_1
L_back_2:
    v_rcp_f32 v98, v98
    v_rcp_f32 v99, v99
    v_pk_mul_f32 v[138:139], v[138:139], v[154:155]
    v_pk_mul_f32 v[136:137], v[136:137], v[96:97]
    v_pk_mul_f32 v[138:139], v[138:139], v[98:99]
    s_add_u32 m0, s21, 86784
    v_cvt_pk_bf16_f32 v80, v136, v137
    v_cvt_pk_bf16_f32 v81, v138, v139
    v_pk_mul_f32 v[100:101], v[168:169], s[68:69] op_sel_hi:[1,0]
L_pg3:
    s_cbranch_execz L_pg7
    s_nop 0
    v_pk_mul_f32 v[102:103], v[170:171], s[68:69] op_sel_hi:[1,0]
    v_exp_f32 v100, v100
    buffer_load_dwordx4 v2, s[40:43], s20 offen offset:0 sc1 lds
    v_exp_f32 v101, v101
    v_exp_f32 v102, v102
    v_exp_f32 v103, v103
    v_pk_mul_f32 v[168:169], v[168:169], v[184:185]
    v_pk_add_f32 v[100:101], v[100:101], 1.0 op_sel_hi:[1,0]
    buffer_load_dwordx4 v2, s[40:43], s20 offen offset:1024 sc1 lds
    v_pk_add_f32 v[102:103], v[102:103], 1.0 op_sel_hi:[1,0]
    v_rcp_f32 v100, v100
    v_rcp_f32 v101, v101
    v_rcp_f32 v102, v102
    v_rcp_f32 v103, v103
    v_pk_mul_f32 v[170:171], v[170:171], v[186:187]
    v_pk_mul_f32 v[168:169], v[168:169], v[100:101]
    v_pk_mul_f32 v[170:171], v[170:171], v[102:103]
    v_cvt_pk_bf16_f32 v82, v168, v169
    v_cvt_pk_bf16_f32 v83, v170, v171
    buffer_store_dwordx4 v[80:83], v2, s[40:43], s15 offen offset:0 sc1
    v_pk_mul_f32 v[96:97], v[140:141], s[68:69] op_sel_hi:[1,0]
    v_pk_mul_f32 v[98:99], v[142:143], s[68:69] op_sel_hi:[1,0]
    v_exp_f32 v96, v96
    v_exp_f32 v97, v97
    v_exp_f32 v98, v98
    v_exp_f32 v99, v99
    v_pk_mul_f32 v[140:141], v[140:141], v[156:157]
    v_pk_add_f32 v[96:97], v[96:97], 1.0 op_sel_hi:[1,0]
    v_pk_add_f32 v[98:99], v[98:99], 1.0 op_sel_hi:[1,0]
    v_rcp_f32 v96, v96
    v_rcp_f32 v97, v97
    v_rcp_f32 v98, v98
    v_rcp_f32 v99, v99
    v_pk_mul_f32 v[142:143], v[142:143], v[158:159]
    v_pk_mul_f32 v[140:141], v[140:141], v[96:97]
    v_pk_mul_f32 v[142:143], v[142:143], v[98:99]
    v_cvt_pk_bf16_f32 v88, v140, v141
    v_cvt_pk_bf16_f32 v89, v142, v143
    v_pk_mul_f32 v[100:101], v[172:173], s[68:69] op_sel_hi:[1,0]
    v_pk_mul_f32 v[102:103], v[174:175], s[68:69] op_sel_hi:[1,0]
    v_exp_f32 v100, v100
    v_exp_f32 v101, v101
    v_exp_f32 v102, v102
    v_exp_f32 v103, v103
    v_pk_mul_f32 v[172:173], v[172:173], v[188:189]
    v_pk_add_f32 v[100:101], v[100:101], 1.0 op_sel_hi:[1,0]
    v_pk_add_f32 v[102:103], v[102:103], 1.0 op_sel_hi:[1,0]
    v_rcp_f32 v100, v100
    v_rcp_f32 v101, v101
    v_rcp_f32 v102, v102
    v_rcp_f32 v103, v103
    v_pk_mul_f32 v[174:175], v[174:175], v[190:191]
    v_pk_mul_f32 v[172:173], v[172:173], v[100:101]
    v_pk_mul_f32 v[174:175], v[174:175], v[102:103]
    v_cvt_pk_bf16_f32 v90, v172, v173
    v_cvt_pk_bf16_f32 v91, v174, v175
    buffer_store_dwordx4 v[88:91], v2, s[40:43], s15 offen offset:2048 sc1
    v_pk_mul_f32 v[96:97], v[192:193], s[68:69] op_sel_hi:[1,0]
    v_pk_mul_f32 v[98:99], v[194:195], s[68:69] op_sel_hi:[1,0]
    v_exp_f32 v96, v96
    v_exp_f32 v97, v97
    v_exp_f32 v98, v98
    v_exp_f32 v99, v99
    v_pk_mul_f32 v[192:193], v[192:193], v[208:209]
    v_pk_add_f32 v[96:97], v[96:97], 1.0 op_sel_hi:[1,0]
    v_pk_add_f32 v[98:99], v[98:99], 1.0 op_sel_hi:[1,0]
    v_rcp_f32 v96, v96
    v_rcp_f32 v97, v97
    ds_write_b128 v22, v[24:27] offset:3072
    v_rcp_f32 v98, v98
    v_rcp_f32 v99, v99
    v_pk_mul_f32 v[194:195], v[194:195], v[210:211]
    v_pk_mul_f32 v[192:193], v[192:193], v[96:97]
    v_pk_mul_f32 v[194:195], v[194:195], v[98:99]
    v_cvt_pk_bf16_f32 v68, v192, v193
    v_cvt_pk_bf16_f32 v69, v194, v195
    v_pk_mul_f32 v[100:101], v[224:225], s[68:69] op_sel_hi:[1,0]
    v_pk_mul_f32 v[102:103], v[226:227], s[68:69] op_sel_hi:[1,0]
    v_exp_f32 v100, v100
    v_exp_f32 v101, v101
    v_exp_f32 v102, v102
    v_exp_f32 v103, v103
    v_pk_mul_f32 v[224:225], v[224:225], v[240:241]
    v_pk_add_f32 v[100:101], v[100:101], 1.0 op_sel_hi:[1,0]
    v_pk_add_f32 v[102:103], v[102:103], 1.0 op_sel_hi:[1,0]
    v_rcp_f32 v100, v100
    v_rcp_f32 v101, v101
    ds_write_b128 v22, v[28:31] offset:2048
    v_rcp_f32 v102, v102
    v_rcp_f32 v103, v103
    v_pk_mul_f32 v[226:227], v[226:227], v[242:243]
    v_pk_mul_f32 v[224:225], v[224:225], v[100:101]
    v_pk_mul_f32 v[226:227], v[226:227], v[102:103]
    v_cvt_pk_bf16_f32 v70, v224, v225
    v_cvt_pk_bf16_f32 v71, v226, v227
    buffer_store_dwordx4 v[68:71], v2, s[40:43], s14 offen offset:1024 sc1
    v_pk_mul_f32 v[96:97], v[196:197], s[68:69] op_sel_hi:[1,0]
    v_pk_mul_f32 v[98:99], v[198:199], s[68:69] op_sel_hi:[1,0]
    v_exp_f32 v96, v96
    v_exp_f32 v97, v97
    v_exp_f32 v98, v98
    v_exp_f32 v99, v99
    v_pk_mul_f32 v[196:197], v[196:197], v[212:213]
    v_pk_add_f32 v[96:97], v[96:97], 1.0 op_sel_hi:[1,0]
    v_pk_add_f32 v[98:99], v[98:99], 1.0 op_sel_hi:[1,0]
    v_rcp_f32 v96, v96
    ds_write_b128 v23, v[52:55] offset:512
    v_rcp_f32 v97, v97
    v_rcp_f32 v98, v98
    v_rcp_f32 v99, v99
    v_pk_mul_f32 v[198:199], v[198:199], v[214:215]
    v_pk_mul_f32 v[196:197], v[196:197], v[96:97]
    v_pk_mul_f32 v[198:199], v[198:199], v[98:99]
    v_cvt_pk_bf16_f32 v76, v196, v197
    v_cvt_pk_bf16_f32 v77, v198, v199
    v_pk_mul_f32 v[100:101], v[228:229], s[68:69] op_sel_hi:[1,0]
    v_pk_mul_f32 v[102:103], v[230:231], s[68:69] op_sel_hi:[1,0]
    v_exp_f32 v100, v100
    v_exp_f32 v101, v101
    v_exp_f32 v102, v102
    v_exp_f32 v103, v103
    v_pk_mul_f32 v[228:229], v[228:229], v[244:245]
    v_pk_add_f32 v[100:101], v[100:101], 1.0 op_sel_hi:[1,0]
    v_pk_add_f32 v[102:103], v[102:103], 1.0 op_sel_hi:[1,0]
    v_rcp_f32 v100, v100
    v_rcp_f32 v101, v101
    ds_write_b128 v23, v[56:59] offset:0
    v_rcp_f32 v102, v102
    v_rcp_f32 v103, v103
    v_pk_mul_f32 v[230:231], v[230:231], v[246:247]
    v_pk_mul_f32 v[228:229], v[228:229], v[100:101]
    v_pk_mul_f32 v[230:231], v[230:231], v[102:103]
    v_cvt_pk_bf16_f32 v78, v228, v229
    v_cvt_pk_bf16_f32 v79, v230, v231
    buffer_store_dwordx4 v[76:79], v2, s[40:43], s14 offen offset:3072 sc1
    v_pk_mul_f32 v[96:97], v[200:201], s[68:69] op_sel_hi:[1,0]
    v_pk_mul_f32 v[98:99], v[202:203], s[68:69] op_sel_hi:[1,0]
    v_exp_f32 v96, v96
    v_exp_f32 v97, v97
    v_exp_f32 v98, v98
    v_exp_f32 v99, v99
    v_pk_mul_f32 v[200:201], v[200:201], v[216:217]
    v_pk_add_f32 v[96:97], v[96:97], 1.0 op_sel_hi:[1,0]
    v_pk_add_f32 v[98:99], v[98:99], 1.0 op_sel_hi:[1,0]
    v_rcp_f32 v96, v96
    s_mov_b32 exec_hi, 0
    s_mov_b32 exec_lo, 0xff000000
    ds_write_b32 v33, v32
    s_mov_b64 exec, -1
    v_rcp_f32 v97, v97
    v_rcp_f32 v98, v98
    v_rcp_f32 v99, v99
    v_pk_mul_f32 v[202:203], v[202:203], v[218:219]
    v_pk_mul_f32 v[200:201], v[200:201], v[96:97]
    v_pk_mul_f32 v[202:203], v[202:203], v[98:99]
    v_cvt_pk_bf16_f32 v84, v200, v201
    v_cvt_pk_bf16_f32 v85, v202, v203
    v_pk_mul_f32 v[100:101], v[232:233], s[68:69] op_sel_hi:[1,0]
    v_pk_mul_f32 v[102:103], v[234:235], s[68:69] op_sel_hi:[1,0]
    v_exp_f32 v100, v100
    v_exp_f32 v101, v101
L_pg4:
    s_cbranch_execz L_pgback
    s_nop 0
    v_exp_f32 v102, v102
    v_exp_f32 v103, v103
    v_pk_mul_f32 v[232:233], v[232:233], v[248:249]
    v_pk_add_f32 v[100:101], v[100:101], 1.0 op_sel_hi:[1,0]
    v_pk_add_f32 v[102:103], v[102:103], 1.0 op_sel_hi:[1,0]
    v_rcp_f32 v100, v100
    ds_write_b32 v48, v47
    v_rcp_f32 v101, v101
    v_rcp_f32 v102, v102
    v_rcp_f32 v103, v103
    v_pk_mul_f32 v[234:235], v[234:235], v[250:251]
    v_pk_mul_f32 v[232:233], v[232:233], v[100:101]
    v_pk_mul_f32 v[234:235], v[234:235], v[102:103]
    v_cvt_pk_bf16_f32 v86, v232, v233
    v_cvt_pk_bf16_f32 v87, v234, v235
    buffer_store_dwordx4 v[84:87], v2, s[40:43], s15 offen offset:1024 sc1
    v_pk_mul_f32 v[96:97], v[204:205], s[68:69] op_sel_hi:[1,0]
    v_pk_mul_f32 v[98:99], v[206:207], s[68:69] op_sel_hi:[1,0]
    v_exp_f32 v96, v96
    v_exp_f32 v97, v97
    v_exp_f32 v98, v98
    v_exp_f32 v99, v99
    v_pk_mul_f32 v[204:205], v[204:205], v[220:221]
    v_pk_add_f32 v[96:97], v[96:97], 1.0 op_sel_hi:[1,0]
    v_pk_add_f32 v[98:99], v[98:99], 1.0 op_sel_hi:[1,0]
    v_rcp_f32 v96, v96
    v_rcp_f32 v97, v97
    v_rcp_f32 v98, v98
    v_rcp_f32 v99, v99
    v_pk_mul_f32 v[206:207], v[206:207], v[222:223]
    v_pk_mul_f32 v[204:205], v[204:205], v[96:97]
    v_pk_mul_f32 v[206:207], v[206:207], v[98:99]
    v_cvt_pk_bf16_f32 v92, v204, v205
    v_cvt_pk_bf16_f32 v93, v206, v207
    v_pk_mul_f32 v[100:101], v[236:237], s[68:69] op_sel_hi:[1,0]
    v_pk_mul_f32 v[102:103], v[238:239], s[68:69] op_sel_hi:[1,0]
    v_exp_f32 v100, v100
    v_exp_f32 v101, v101
    v_exp_f32 v102, v102
    v_exp_f32 v103, v103
    v_pk_mul_f32 v[236:237], v[236:237], v[252:253]
    v_pk_add_f32 v[100:101], v[100:101], 1.0 op_sel_hi:[1,0]
    v_pk_add_f32 v[102:103], v[102:103], 1.0 op_sel_hi:[1,0]
    v_rcp_f32 v100, v100
    v_rcp_f32 v101, v101
    v_rcp_f32 v102, v102
    v_rcp_f32 v103, v103
    v_pk_mul_f32 v[238:239], v[238:239], v[254:255]
    v_pk_mul_f32 v[236:237], v[236:237], v[100:101]
    v_pk_mul_f32 v[238:239], v[238:239], v[102:103]
    v_cvt_pk_bf16_f32 v94, v236, v237
    v_cvt_pk_bf16_f32 v95, v238, v239
    buffer_store_dwordx4 v[92:95], v2, s[40:43], s15 offen offset:3072 sc1
L_join:
    s_waitcnt vmcnt(6) lgkmcnt(0)
    s_barrier
    ds_read2_b32 v[128:129], v4 offset0:176 offset1:177
    ds_read2_b32 v[130:131], v4 offset0:178 offset1:179
    ds_read_b128 v[160:163], v8 offset:192
    ds_read2_b32 v[132:133], v4 offset0:48 offset1:49
    ds_read2_b32 v[134:135], v4 offset0:50 offset1:51
    ds_read_b128 v[164:167], v8 offset:704
    ds_read2_b32 v[136:137], v5 offset0:176 offset1:177
    ds_read2_b32 v[138:139], v5 offset0:178 offset1:179
    ds_read_b128 v[168:171], v8 offset:1216
    s_waitcnt lgkmcnt(6)
    v_mfma_f32_16x16x32_bf16 v[96:99], v[128:131], v[160:163], 0
    s_add_u32 m0, s13, 98304
    ds_read2_b32 v[140:141], v5 offset0:48 offset1:49
    s_waitcnt lgkmcnt(4)
    v_mfma_f32_16x16x32_bf16 v[100:103], v[128:131], v[164:167], 0
    buffer_load_dwordx4 v34, s[44:47], s12 offen offset:0 lds
    v_mfma_f32_16x16x32_bf16 v[100:103], v[132:135], v[160:163], v[100:103]
    ds_read2_b32 v[142:143], v5 offset0:50 offset1:51
    s_mov_b32 s54, s19
    v_mfma_f32_16x16x32_bf16 v[104:107], v[132:135], v[164:167], 0
    ds_read_b128 v[172:175], v8 offset:1728
    s_mov_b32 s55, s19
    s_waitcnt lgkmcnt(3)
    v_mfma_f32_16x16x32_bf16 v[104:107], v[128:131], v[168:171], v[104:107]
    ds_read2_b32 v[144:145], v6 offset0:176 offset1:177
    s_add_u32 s58, s1, 0
    v_mfma_f32_16x16x32_bf16 v[108:111], v[132:135], v[168:171], 0
    buffer_load_dwordx4 v35, s[44:47], s12 offen offset:1024 lds
    v_mfma_f32_16x16x32_bf16 v[104:107], v[136:139], v[160:163], v[104:107]
    ds_read2_b32 v[146:147], v6 offset0:178 offset1:179
    s_sub_u32 s59, s58, 7
    v_mfma_f32_16x16x32_bf16 v[108:111], v[136:139], v[164:167], v[108:111]
    ds_read_b128 v[176:179], v8 offset:2240
    s_min_u32 s58, s58, s59
    v_mfma_f32_16x16x32_bf16 v[112:115], v[136:139], v[168:171], 0
    ds_read2_b32 v[148:149], v6 offset0:48 offset1:49
    v_lshl_add_u32 v16, s58, 13, v2
    s_waitcnt lgkmcnt(4)
    v_mfma_f32_16x16x32_bf16 v[108:111], v[128:131], v[172:175], v[108:111]
    buffer_load_dwordx4 v36, s[44:47], s12 offen offset:2048 lds
    v_mfma_f32_16x16x32_bf16 v[112:115], v[132:135], v[172:175], v[112:115]
    ds_read2_b32 v[150:151], v6 offset0:50 offset1:51
    s_add_u32 s58, s1, 1
    v_mfma_f32_16x16x32_bf16 v[116:119], v[136:139], v[172:175], 0
    ds_read_b128 v[180:183], v8 offset:2752
    s_sub_u32 s59, s58, 7
    v_mfma_f32_16x16x32_bf16 v[108:111], v[140:143], v[160:163], v[108:111]
    ds_read2_b32 v[152:153], v7 offset0:176 offset1:177
    s_min_u32 s58, s58, s59
    v_mfma_f32_16x16x32_bf16 v[112:115], v[140:143], v[164:167], v[112:115]
    buffer_load_dwordx4 v37, s[44:47], s12 offen offset:3072 lds
    v_mfma_f32_16x16x32_bf16 v[116:119], v[140:143], v[168:171], v[116:119]
    s_add_u32 s12, s12, 32768
    ds_read2_b32 v[154:155], v7 offset0:178 offset1:179
    v_mfma_f32_16x16x32_bf16 v[120:123], v[140:143], v[172:175], 0
    ds_read_b128 v[184:187], v8 offset:3264
    v_lshl_add_u32 v17, s58, 13, v2
    s_waitcnt lgkmcnt(6)
    v_mfma_f32_16x16x32_bf16 v[112:115], v[128:131], v[176:179], v[112:115]
    s_add_u32 m0, s13, 114688
    ds_read2_b32 v[156:157], v7 offset0:48 offset1:49
    v_mfma_f32_16x16x32_bf16 v[116:119], v[132:135], v[176:179], v[116:119]
    buffer_load_dwordx4 v34, s[44:47], s12 offen offset:0 lds
    v_mfma_f32_16x16x32_bf16 v[120:123], v[136:139], v[176:179], v[120:123]
    ds_read2_b32 v[158:159], v7 offset0:50 offset1:51
    s_add_u32 s58, s1, 2
    v_mfma_f32_16x16x32_bf16 v[124:127], v[140:143], v[176:179], 0
    ds_read_b128 v[188:191], v8 offset:3776
    s_sub_u32 s59, s58, 7
    v_mfma_f32_16x16x32_bf16 v[112:115], v[144:147], v[160:163], v[112:115]
    ds_read2_b32 v[192:193], v4 offset0:160 offset1:161
    s_min_u32 s58, s58, s59
    v_mfma_f32_16x16x32_bf16 v[116:119], v[144:147], v[164:167], v[116:119]
    buffer_load_dwordx4 v35, s[44:47], s12 offen offset:1024 lds
    v_mfma_f32_16x16x32_bf16 v[120:123], v[144:147], v[168:171], v[120:123]
    ds_read2_b32 v[194:195], v4 offset0:162 offset1:163
    v_lshl_add_u32 v18, s58, 13, v2
    v_mfma_f32_16x16x32_bf16 v[124:127], v[144:147], v[172:175], v[124:127]
    ds_read_b128 v[224:227], v8 offset:128
    s_add_u32 s58, s1, 3
    s_waitcnt lgkmcnt(9)
    v_mfma_f32_16x16x32_bf16 v[116:119], v[128:131], v[180:183], v[116:119]
    ds_read2_b32 v[196:197], v4 offset0:32 offset1:33
    s_sub_u32 s59, s58, 7
    v_mfma_f32_16x16x32_bf16 v[120:123], v[132:135], v[180:183], v[120:123]
    buffer_load_dwordx4 v36, s[44:47], s12 offen offset:2048 lds
    v_mfma_f32_16x16x32_bf16 v[124:127], v[136:139], v[180:183], v[124:127]
    ds_read2_b32 v[198:199], v4 offset0:34 offset1:35
    s_min_u32 s58, s58, s59
    v_mfma_f32_16x16x32_bf16 v[116:119], v[148:151], v[160:163], v[116:119]
    ds_read_b128 v[228:231], v8 offset:640
    v_lshl_add_u32 v19, s58, 13, v2
    v_mfma_f32_16x16x32_bf16 v[120:123], v[148:151], v[164:167], v[120:123]
    ds_read2_b32 v[200:201], v5 offset0:160 offset1:161
L_pg5:
    s_cbranch_execz L_pgback
    s_nop 0
    s_add_u32 s58, s1, 4
    v_mfma_f32_16x16x32_bf16 v[124:127], v[148:151], v[168:171], v[124:127]
    buffer_load_dwordx4 v37, s[44:47], s12 offen offset:3072 lds
    s_waitcnt lgkmcnt(10)
    v_mfma_f32_16x16x32_bf16 v[120:123], v[128:131], v[184:187], v[120:123]
    ds_read2_b32 v[202:203], v5 offset0:162 offset1:163
    s_sub_u32 s59, s58, 7
    v_mfma_f32_16x16x32_bf16 v[124:127], v[132:135], v[184:187], v[124:127]
    ds_read_b128 v[232:235], v8 offset:1152
    s_min_u32 s58, s58, s59
    v_mfma_f32_16x16x32_bf16 v[120:123], v[152:155], v[160:163], v[120:123]
    ds_read2_b32 v[204:205], v5 offset0:32 offset1:33
    v_lshl_add_u32 v20, s58, 13, v2
    v_mfma_f32_16x16x32_bf16 v[124:127], v[152:155], v[164:167], v[124:127]
    ds_read2_b32 v[206:207], v5 offset0:34 offset1:35
    s_add_u32 s58, s1, 5
    s_waitcnt lgkmcnt(11)
    v_mfma_f32_16x16x32_bf16 v[124:127], v[128:131], v[188:191], v[124:127]
    ds_read_b128 v[236:239], v8 offset:1664
    s_sub_u32 s59, s58, 7
    v_mfma_f32_16x16x32_bf16 v[124:127], v[156:159], v[160:163], v[124:127]
    ds_read2_b32 v[208:209], v6 offset0:160 offset1:161
    s_min_u32 s58, s58, s59
    s_waitcnt lgkmcnt(10)
    v_mfma_f32_16x16x32_bf16 v[96:99], v[192:195], v[224:227], v[96:99]
    ds_read2_b32 v[210:211], v6 offset0:162 offset1:163
    v_lshl_add_u32 v21, s58, 13, v2
    s_waitcnt lgkmcnt(8)
    v_mfma_f32_16x16x32_bf16 v[100:103], v[192:195], v[228:231], v[100:103]
    ds_read_b128 v[240:243], v8 offset:2176
    s_add_u32 s58, s1, 6
    v_mfma_f32_16x16x32_bf16 v[100:103], v[196:199], v[224:227], v[100:103]
    ds_read2_b32 v[212:213], v6 offset0:32 offset1:33
    s_sub_u32 s59, s58, 7
    v_mfma_f32_16x16x32_bf16 v[104:107], v[196:199], v[228:231], v[104:107]
    ds_read2_b32 v[214:215], v6 offset0:34 offset1:35
    s_min_u32 s58, s58, s59
    s_waitcnt lgkmcnt(8)
    v_mfma_f32_16x16x32_bf16 v[104:107], v[192:195], v[232:235], v[104:107]
    ds_read_b128 v[244:247], v8 offset:2688
    v_lshl_add_u32 v22, s58, 13, v2
    v_mfma_f32_16x16x32_bf16 v[108:111], v[196:199], v[232:235], v[108:111]
    ds_read2_b32 v[216:217], v7 offset0:160 offset1:161
    s_mul_i32 s58, s56, 28
    v_mfma_f32_16x16x32_bf16 v[104:107], v[200:203], v[224:227], v[104:107]
    ds_read2_b32 v[218:219], v7 offset0:162 offset1:163
    s_mul_i32 s59, s3, 7
    v_mfma_f32_16x16x32_bf16 v[108:111], v[200:203], v[228:231], v[108:111]
    ds_read_b128 v[248:251], v8 offset:3200
    s_add_u32 s58, s58, s59
    v_mfma_f32_16x16x32_bf16 v[112:115], v[200:203], v[232:235], v[112:115]
    ds_read2_b32 v[220:221], v7 offset0:32 offset1:33
    s_lshl_b32 s58, s58, 13
    s_waitcnt lgkmcnt(10)
    v_mfma_f32_16x16x32_bf16 v[108:111], v[192:195], v[236:239], v[108:111]
    ds_read2_b32 v[222:223], v7 offset0:34 offset1:35
    s_add_u32 s58, s58, 6291456
    v_mfma_f32_16x16x32_bf16 v[112:115], v[196:199], v[236:239], v[112:115]
    ds_read_b128 v[252:255], v8 offset:3712
    s_add_u32 s60, s3, 1
    v_mfma_f32_16x16x32_bf16 v[116:119], v[200:203], v[236:239], v[116:119]
    ds_read2_b32 v[128:129], v4 offset0:144 offset1:145
    s_and_b32 s60, s60, 3
    v_mfma_f32_16x16x32_bf16 v[108:111], v[204:207], v[224:227], v[108:111]
    ds_read2_b32 v[130:131], v4 offset0:146 offset1:147
    s_lshl_b32 s72, s60, 11
    v_mfma_f32_16x16x32_bf16 v[112:115], v[204:207], v[228:231], v[112:115]
    ds_read_b128 v[160:163], v8 offset:64
    s_add_u32 s72, s72, s58
    v_mfma_f32_16x16x32_bf16 v[116:119], v[204:207], v[232:235], v[116:119]
    ds_read2_b32 v[132:133], v4 offset0:16 offset1:17
    s_add_u32 s60, s3, 2
    v_mfma_f32_16x16x32_bf16 v[120:123], v[204:207], v[236:239], v[120:123]
    ds_read2_b32 v[134:135], v4 offset0:18 offset1:19
    s_and_b32 s60, s60, 3
    s_waitcnt lgkmcnt(8)
    v_mfma_f32_16x16x32_bf16 v[112:115], v[192:195], v[240:243], v[112:115]
    ds_read_b128 v[164:167], v8 offset:576
    s_lshl_b32 s73, s60, 11
    v_mfma_f32_16x16x32_bf16 v[116:119], v[196:199], v[240:243], v[116:119]
    ds_read2_b32 v[136:137], v5 offset0:144 offset1:145
    s_add_u32 s73, s73, s58
    v_mfma_f32_16x16x32_bf16 v[120:123], v[200:203], v[240:243], v[120:123]
    s_waitcnt vmcnt(8)
    s_atomic_swap s19, s[30:31], s16
    s_add_u32 s60, s3, 3
    v_mfma_f32_16x16x32_bf16 v[124:127], v[204:207], v[240:243], v[124:127]
    ds_read2_b32 v[138:139], v5 offset0:146 offset1:147
    s_and_b32 s60, s60, 3
    v_mfma_f32_16x16x32_bf16 v[112:115], v[208:211], v[224:227], v[112:115]
    ds_read_b128 v[168:171], v8 offset:1088
    s_lshl_b32 s74, s60, 11
    v_mfma_f32_16x16x32_bf16 v[116:119], v[208:211], v[228:231], v[116:119]
    ds_read2_b32 v[140:141], v5 offset0:16 offset1:17
    s_add_u32 s74, s74, s58
    v_mfma_f32_16x16x32_bf16 v[120:123], v[208:211], v[232:235], v[120:123]
    ds_read2_b32 v[142:143], v5 offset0:18 offset1:19
    s_add_u32 s60, s3, 4
    v_mfma_f32_16x16x32_bf16 v[124:127], v[208:211], v[236:239], v[124:127]
    ds_read_b128 v[172:175], v8 offset:1600
    s_and_b32 s60, s60, 3
    s_waitcnt lgkmcnt(12)
    v_mfma_f32_16x16x32_bf16 v[116:119], v[192:195], v[244:247], v[116:119]
    ds_read2_b32 v[144:145], v6 offset0:144 offset1:145
    s_lshl_b32 s75, s60, 11
    v_mfma_f32_16x16x32_bf16 v[120:123], v[196:199], v[244:247], v[120:123]
    ds_read2_b32 v[146:147], v6 offset0:146 offset1:147
    s_add_u32 s75, s75, s58
    v_mfma_f32_16x16x32_bf16 v[124:127], v[200:203], v[244:247], v[124:127]
    ds_read_b128 v[176:179], v8 offset:2112
    s_lshl_b32 s63, s56, 5
    v_mfma_f32_16x16x32_bf16 v[116:119], v[212:215], v[224:227], v[116:119]
    ds_read2_b32 v[148:149], v6 offset0:16 offset1:17
    s_add_u32 s63, s63, s59
    v_mfma_f32_16x16x32_bf16 v[120:123], v[212:215], v[228:231], v[120:123]
    ds_read2_b32 v[150:151], v6 offset0:18 offset1:19
    s_lshl_b32 s63, s63, 7
    v_mfma_f32_16x16x32_bf16 v[124:127], v[212:215], v[232:235], v[124:127]
    ds_read_b128 v[180:183], v8 offset:2624
    s_add_u32 s63, s63, 262144
    v_mfma_f32_16x16x32_bf16 v[120:123], v[192:195], v[248:251], v[120:123]
    ds_read2_b32 v[152:153], v7 offset0:144 offset1:145
    v_mfma_f32_16x16x32_bf16 v[124:127], v[196:199], v[248:251], v[124:127]
    ds_read2_b32 v[154:155], v7 offset0:146 offset1:147
    v_mfma_f32_16x16x32_bf16 v[120:123], v[216:219], v[224:227], v[120:123]
    ds_read_b128 v[184:187], v8 offset:3136
    v_mfma_f32_16x16x32_bf16 v[124:127], v[216:219], v[228:231], v[124:127]
    ds_read2_b32 v[156:157], v7 offset0:16 offset1:17
    v_mfma_f32_16x16x32_bf16 v[124:127], v[192:195], v[252:255], v[124:127]
    ds_read2_b32 v[158:159], v7 offset0:18 offset1:19
    v_mfma_f32_16x16x32_bf16 v[124:127], v[220:223], v[224:227], v[124:127]
    ds_read_b128 v[188:191], v8 offset:3648
    s_waitcnt lgkmcnt(9)
    v_mfma_f32_16x16x32_bf16 v[96:99], v[128:131], v[160:163], v[96:99]
    ds_read2_b32 v[192:193], v4 offset0:128 offset1:129
    v_mfma_f32_16x16x32_bf16 v[100:103], v[128:131], v[164:167], v[100:103]
    ds_read2_b32 v[194:195], v4 offset0:130 offset1:131
    v_mfma_f32_16x16x32_bf16 v[100:103], v[132:135], v[160:163], v[100:103]
    ds_read_b128 v[224:227], v8 offset:0
    v_mfma_f32_16x16x32_bf16 v[104:107], v[132:135], v[164:167], v[104:107]
    ds_read2_b32 v[196:197], v4 offset0:0 offset1:1
    s_waitcnt lgkmcnt(10)
    v_mfma_f32_16x16x32_bf16 v[104:107], v[128:131], v[168:171], v[104:107]
    s_load_dword s32, s[30:31], s63 offset:0 glc
    s_load_dword s33, s[30:31], s63 offset:128 glc
    s_load_dword s34, s[30:31], s63 offset:256 glc
    v_mfma_f32_16x16x32_bf16 v[108:111], v[132:135], v[168:171], v[108:111]
    s_load_dword s35, s[30:31], s63 offset:384 glc
    s_load_dword s36, s[30:31], s63 offset:512 glc
L_pg6:
    s_cbranch_execz L_pgback
    s_nop 0
    s_load_dword s37, s[30:31], s63 offset:640 glc
    v_mfma_f32_16x16x32_bf16 v[104:107], v[136:139], v[160:163], v[104:107]
    s_load_dword s38, s[30:31], s63 offset:768 glc
    ds_read2_b32 v[198:199], v4 offset0:2 offset1:3
    v_mfma_f32_16x16x32_bf16 v[108:111], v[136:139], v[164:167], v[108:111]
    ds_read_b128 v[228:231], v8 offset:512
    v_mfma_f32_16x16x32_bf16 v[112:115], v[136:139], v[168:171], v[112:115]
    ds_read2_b32 v[200:201], v5 offset0:128 offset1:129
    s_waitcnt lgkmcnt(10)
    v_mfma_f32_16x16x32_bf16 v[108:111], v[128:131], v[172:175], v[108:111]
    ds_read2_b32 v[202:203], v5 offset0:130 offset1:131
    v_mfma_f32_16x16x32_bf16 v[112:115], v[132:135], v[172:175], v[112:115]
    ds_read_b128 v[232:235], v8 offset:1024
    v_mfma_f32_16x16x32_bf16 v[116:119], v[136:139], v[172:175], v[116:119]
    ds_read2_b32 v[204:205], v5 offset0:0 offset1:1
    v_mfma_f32_16x16x32_bf16 v[108:111], v[140:143], v[160:163], v[108:111]
    ds_read2_b32 v[206:207], v5 offset0:2 offset1:3
    v_mfma_f32_16x16x32_bf16 v[112:115], v[140:143], v[164:167], v[112:115]
    ds_read_b128 v[236:239], v8 offset:1536
    v_mfma_f32_16x16x32_bf16 v[116:119], v[140:143], v[168:171], v[116:119]
    ds_read2_b32 v[208:209], v6 offset0:128 offset1:129
    v_mfma_f32_16x16x32_bf16 v[120:123], v[140:143], v[172:175], v[120:123]
    ds_read2_b32 v[210:211], v6 offset0:130 offset1:131
    s_waitcnt lgkmcnt(14)
    v_mfma_f32_16x16x32_bf16 v[112:115], v[128:131], v[176:179], v[112:115]
    ds_read_b128 v[240:243], v8 offset:2048
    v_mfma_f32_16x16x32_bf16 v[116:119], v[132:135], v[176:179], v[116:119]
    ds_read2_b32 v[212:213], v6 offset0:0 offset1:1
    v_mfma_f32_16x16x32_bf16 v[120:123], v[136:139], v[176:179], v[120:123]
    ds_read2_b32 v[214:215], v6 offset0:2 offset1:3
    v_mfma_f32_16x16x32_bf16 v[124:127], v[140:143], v[176:179], v[124:127]
    ds_read_b128 v[244:247], v8 offset:2560
    v_mfma_f32_16x16x32_bf16 v[112:115], v[144:147], v[160:163], v[112:115]
    ds_read2_b32 v[216:217], v7 offset0:128 offset1:129
    v_mfma_f32_16x16x32_bf16 v[116:119], v[144:147], v[164:167], v[116:119]
    ds_read2_b32 v[218:219], v7 offset0:130 offset1:131
    v_mfma_f32_16x16x32_bf16 v[120:123], v[144:147], v[168:171], v[120:123]
    ds_read_b128 v[248:251], v8 offset:3072
    v_mfma_f32_16x16x32_bf16 v[124:127], v[144:147], v[172:175], v[124:127]
    ds_read2_b32 v[220:221], v7 offset0:0 offset1:1
    v_mfma_f32_16x16x32_bf16 v[116:119], v[128:131], v[180:183], v[116:119]
    ds_read2_b32 v[222:223], v7 offset0:2 offset1:3
    v_mfma_f32_16x16x32_bf16 v[120:123], v[132:135], v[180:183], v[120:123]
    ds_read_b128 v[252:255], v8 offset:3584
    v_mfma_f32_16x16x32_bf16 v[124:127], v[136:139], v[180:183], v[124:127]
    ds_read_b64_tr_b16 a[128:129], v38 offset:0
    v_mfma_f32_16x16x32_bf16 v[116:119], v[148:151], v[160:163], v[116:119]
    ds_read_b64_tr_b16 a[132:133], v39 offset:0
    v_mfma_f32_16x16x32_bf16 v[120:123], v[148:151], v[164:167], v[120:123]
    ds_read_b64_tr_b16 a[136:137], v40 offset:0
    v_mfma_f32_16x16x32_bf16 v[124:127], v[148:151], v[168:171], v[124:127]
    ds_read_b64_tr_b16 a[140:141], v41 offset:0
    v_mfma_f32_16x16x32_bf16 v[120:123], v[128:131], v[184:187], v[120:123]
    ds_read_b64_tr_b16 a[130:131], v38 offset:2048
    v_mfma_f32_16x16x32_bf16 v[124:127], v[132:135], v[184:187], v[124:127]
    ds_read_b64_tr_b16 a[134:135], v39 offset:2048
    v_mfma_f32_16x16x32_bf16 v[120:123], v[152:155], v[160:163], v[120:123]
    ds_read_b64_tr_b16 a[138:139], v40 offset:2048
    v_mfma_f32_16x16x32_bf16 v[124:127], v[152:155], v[164:167], v[124:127]
    ds_read_b64_tr_b16 a[142:143], v41 offset:2048
    v_mfma_f32_16x16x32_bf16 v[124:127], v[128:131], v[188:191], v[124:127]
    ds_read_b64_tr_b16 a[144:145], v38 offset:16384
    v_mfma_f32_16x16x32_bf16 v[124:127], v[156:159], v[160:163], v[124:127]
    ds_read_b64_tr_b16 a[148:149], v39 offset:16384
    s_waitcnt lgkmcnt(0)
    s_xor_b64 s[32:33], s[32:33], s[54:55]
    s_xor_b64 s[34:35], s[34:35], s[54:55]
    s_or_b64 s[32:33], s[32:33], s[34:35]
    s_xor_b64 s[36:37], s[36:37], s[54:55]
    s_or_b64 s[32:33], s[32:33], s[36:37]
    s_xor_b32 s38, s38, s19
    s_or_b32 s32, s32, s38
    s_or_b32 s32, s32, s33
    s_cselect_b32 s14, 14680064, s72
    s_cselect_b32 s25, 1, 0
    s_cmp_eq_u32 s77, 0
    s_cbranch_scc0 L_c3b
    v_mfma_f32_16x16x32_bf16 v[124:127], v[192:195], v[252:255], v[124:127]
    buffer_load_dwordx4 v[128:131], v16, s[40:43], s14 offen offset:0 sc1
    v_mfma_f32_16x16x32_bf16 v[124:127], v[196:199], v[248:251], v[124:127]
    ds_read_b64 v[80:81], v11 offset:0
    v_mfma_f32_16x16x32_bf16 v[124:127], v[200:203], v[244:247], v[124:127]
    ds_read_b64 v[82:83], v11 offset:512
    v_mfma_f32_16x16x32_bf16 v[124:127], v[204:207], v[240:243], v[124:127]
    ds_read_b64 v[84:85], v11 offset:1024
    v_mfma_f32_16x16x32_bf16 v[124:127], v[208:211], v[236:239], v[124:127]
    buffer_load_dwordx4 v[132:135], v16, s[40:43], s14 offen offset:1024 sc1
    v_mfma_f32_16x16x32_bf16 v[124:127], v[212:215], v[232:235], v[124:127]
    ds_read_b64 v[86:87], v11 offset:1536
    v_mfma_f32_16x16x32_bf16 v[124:127], v[216:219], v[228:231], v[124:127]
    s_cmp_eq_u32 s25, 0
    s_cbranch_scc1 L_ag_3
    s_load_dword s32, s[30:31], s63 offset:0 glc
    s_load_dword s33, s[30:31], s63 offset:128 glc
    s_load_dword s34, s[30:31], s63 offset:256 glc
    s_load_dword s35, s[30:31], s63 offset:384 glc
    s_load_dword s36, s[30:31], s63 offset:512 glc
    s_load_dword s37, s[30:31], s63 offset:640 glc
    s_load_dword s38, s[30:31], s63 offset:768 glc
L_ag_3:
    v_mfma_f32_16x16x32_bf16 v[124:127], v[220:223], v[224:227], v[124:127]
    ds_read_b64_tr_b16 a[152:153], v40 offset:16384
    v_mfma_f32_16x16x32_bf16 v[120:123], v[192:195], v[248:251], v[120:123]
    buffer_load_dwordx4 v[136:139], v17, s[40:43], s14 offen offset:0 sc1
    v_mfma_f32_16x16x32_bf16 v[120:123], v[196:199], v[244:247], v[120:123]
    ds_read_b64_tr_b16 a[156:157], v41 offset:16384
    v_mfma_f32_16x16x32_bf16 v[120:123], v[200:203], v[240:243], v[120:123]
    ds_read_b64_tr_b16 a[146:147], v38 offset:18432
    v_mfma_f32_16x16x32_bf16 v[120:123], v[204:207], v[236:239], v[120:123]
    ds_read_b64_tr_b16 a[150:151], v39 offset:18432
    v_mfma_f32_16x16x32_bf16 v[120:123], v[208:211], v[232:235], v[120:123]
    buffer_load_dwordx4 v[140:143], v17, s[40:43], s14 offen offset:1024 sc1
    v_mfma_f32_16x16x32_bf16 v[120:123], v[212:215], v[228:231], v[120:123]
    ds_read_b64_tr_b16 a[154:155], v40 offset:18432
    v_mfma_f32_16x16x32_bf16 v[120:123], v[216:219], v[224:227], v[120:123]
    ds_read_b64_tr_b16 a[158:159], v41 offset:18432
    v_mfma_f32_16x16x32_bf16 v[116:119], v[192:195], v[244:247], v[116:119]
    ds_write_b128 v9, v[124:127] offset:3072
    v_mfma_f32_16x16x32_bf16 v[116:119], v[196:199], v[240:243], v[116:119]
    buffer_load_dwordx4 v[144:147], v18, s[40:43], s14 offen offset:0 sc1
    v_mfma_f32_16x16x32_bf16 v[116:119], v[200:203], v[236:239], v[116:119]
    ds_read_b64_tr_b16 a[160:161], v38 offset:32768
    v_mfma_f32_16x16x32_bf16 v[116:119], v[204:207], v[232:235], v[116:119]
    ds_read_b64_tr_b16 a[164:165], v39 offset:32768
    v_mfma_f32_16x16x32_bf16 v[116:119], v[208:211], v[228:231], v[116:119]
    ds_read_b64_tr_b16 a[168:169], v40 offset:32768
    v_mfma_f32_16x16x32_bf16 v[116:119], v[212:215], v[224:227], v[116:119]
    buffer_load_dwordx4 v[148:151], v18, s[40:43], s14 offen offset:1024 sc1
    v_mfma_f32_16x16x32_bf16 v[112:115], v[192:195], v[240:243], v[112:115]
    ds_read_b64_tr_b16 a[172:173], v41 offset:32768
    v_mfma_f32_16x16x32_bf16 v[112:115], v[196:199], v[236:239], v[112:115]
    ds_write_b128 v9, v[120:123] offset:2048
    v_mfma_f32_16x16x32_bf16 v[112:115], v[200:203], v[232:235], v[112:115]
    ds_read_b64_tr_b16 a[162:163], v38 offset:34816
    v_mfma_f32_16x16x32_bf16 v[112:115], v[204:207], v[228:231], v[112:115]
    buffer_load_dwordx4 v[152:155], v19, s[40:43], s14 offen offset:0 sc1
    v_mfma_f32_16x16x32_bf16 v[112:115], v[208:211], v[224:227], v[112:115]
    ds_read_b64_tr_b16 a[166:167], v39 offset:34816
    v_mfma_f32_16x16x32_bf16 v[108:111], v[192:195], v[236:239], v[108:111]
    ds_read_b64_tr_b16 a[170:171], v40 offset:34816
    v_mfma_f32_16x16x32_bf16 v[108:111], v[196:199], v[232:235], v[108:111]
    ds_read_b64_tr_b16 a[174:175], v41 offset:34816
    v_mfma_f32_16x16x32_bf16 v[108:111], v[200:203], v[228:231], v[108:111]
    buffer_load_dwordx4 v[156:159], v19, s[40:43], s14 offen offset:1024 sc1
    v_mfma_f32_16x16x32_bf16 v[76:79], v[204:207], v[224:227], v[108:111]
    ds_write_b128 v9, v[116:119] offset:1024
    v_mfma_f32_16x16x32_bf16 v[104:107], v[192:195], v[232:235], v[104:107]
    ds_read_b64_tr_b16 a[176:177], v38 offset:49152
    v_mfma_f32_16x16x32_bf16 v[104:107], v[196:199], v[228:231], v[104:107]
    ds_read_b64_tr_b16 a[180:181], v39 offset:49152
    v_mfma_f32_16x16x32_bf16 v[72:75], v[200:203], v[224:227], v[104:107]
    ds_read_b64_tr_b16 a[184:185], v40 offset:49152
    v_mfma_f32_16x16x32_bf16 v[100:103], v[192:195], v[228:231], v[100:103]
    ds_write_b128 v9, v[112:115] offset:0
    v_mfma_f32_16x16x32_bf16 v[68:71], v[196:199], v[224:227], v[100:103]
    v_mfma_f32_16x16x32_bf16 v[64:67], v[192:195], v[224:227], v[96:99]
    s_waitcnt lgkmcnt(0)
    s_branch L_c3j
L_c3b:
    v_mfma_f32_16x16x32_bf16 v[108:111], v[192:195], v[236:239], v[108:111]
    buffer_load_dwordx4 v[128:131], v16, s[40:43], s14 offen offset:0 sc1
    v_mfma_f32_16x16x32_bf16 v[108:111], v[196:199], v[232:235], v[108:111]
    ds_read_b64 v[80:81], v11 offset:0
    v_mfma_f32_16x16x32_bf16 v[108:111], v[200:203], v[228:231], v[108:111]
    ds_read_b64 v[82:83], v11 offset:512
    v_mfma_f32_16x16x32_bf16 v[108:111], v[204:207], v[224:227], v[108:111]
    ds_read_b64 v[84:85], v11 offset:1024
    v_mfma_f32_16x16x32_bf16 v[104:107], v[192:195], v[232:235], v[104:107]
    buffer_load_dwordx4 v[132:135], v16, s[40:43], s14 offen offset:1024 sc1
    v_mfma_f32_16x16x32_bf16 v[104:107], v[196:199], v[228:231], v[104:107]
    ds_read_b64 v[86:87], v11 offset:1536
    v_mfma_f32_16x16x32_bf16 v[104:107], v[200:203], v[224:227], v[104:107]
    s_cmp_eq_u32 s25, 0
    s_cbranch_scc1 L_ag_4
    s_load_dword s32, s[30:31], s63 offset:0 glc
    s_load_dword s33, s[30:31], s63 offset:128 glc
    s_load_dword s34, s[30:31], s63 offset:256 glc
    s_load_dword s35, s[30:31], s63 offset:384 glc
    s_load_dword s36, s[30:31], s63 offset:512 glc
    s_load_dword s37, s[30:31], s63 offset:640 glc
    s_load_dword s38, s[30:31], s63 offset:768 glc
L_ag_4:
    v_mfma_f32_16x16x32_bf16 v[100:103], v[192:195], v[228:231], v[100:103]
    ds_read_b64_tr_b16 a[152:153], v40 offset:16384
    v_mfma_f32_16x16x32_bf16 v[100:103], v[196:199], v[224:227], v[100:103]
    buffer_load_dwordx4 v[136:139], v17, s[40:43], s14 offen offset:0 sc1
    v_mfma_f32_16x16x32_bf16 v[96:99], v[192:195], v[224:227], v[96:99]
    ds_read_b64_tr_b16 a[156:157], v41 offset:16384
    v_mfma_f32_16x16x32_bf16 v[124:127], v[192:195], v[252:255], v[124:127]
    ds_read_b64_tr_b16 a[146:147], v38 offset:18432
    v_mfma_f32_16x16x32_bf16 v[124:127], v[196:199], v[248:251], v[124:127]
    ds_write_b128 v9, v[108:111] offset:3072
    v_mfma_f32_16x16x32_bf16 v[124:127], v[200:203], v[244:247], v[124:127]
    buffer_load_dwordx4 v[140:143], v17, s[40:43], s14 offen offset:1024 sc1
    v_mfma_f32_16x16x32_bf16 v[124:127], v[204:207], v[240:243], v[124:127]
    ds_read_b64_tr_b16 a[150:151], v39 offset:18432
    v_mfma_f32_16x16x32_bf16 v[124:127], v[208:211], v[236:239], v[124:127]
    ds_write_b128 v9, v[104:107] offset:2048
    v_mfma_f32_16x16x32_bf16 v[124:127], v[212:215], v[232:235], v[124:127]
    ds_read_b64_tr_b16 a[154:155], v40 offset:18432
    v_mfma_f32_16x16x32_bf16 v[124:127], v[216:219], v[228:231], v[124:127]
    buffer_load_dwordx4 v[144:147], v18, s[40:43], s14 offen offset:0 sc1
    v_mfma_f32_16x16x32_bf16 v[76:79], v[220:223], v[224:227], v[124:127]
    ds_write_b128 v9, v[100:103] offset:1024
    v_mfma_f32_16x16x32_bf16 v[120:123], v[192:195], v[248:251], v[120:123]
    ds_write_b128 v9, v[96:99] offset:0
    v_mfma_f32_16x16x32_bf16 v[120:123], v[196:199], v[244:247], v[120:123]
    ds_read_b64_tr_b16 a[158:159], v41 offset:18432
    v_mfma_f32_16x16x32_bf16 v[120:123], v[200:203], v[240:243], v[120:123]
    buffer_load_dwordx4 v[148:151], v18, s[40:43], s14 offen offset:1024 sc1
    v_mfma_f32_16x16x32_bf16 v[120:123], v[204:207], v[236:239], v[120:123]
    ds_read_b64_tr_b16 a[160:161], v38 offset:32768
    v_mfma_f32_16x16x32_bf16 v[120:123], v[208:211], v[232:235], v[120:123]
    ds_read_b64_tr_b16 a[164:165], v39 offset:32768
    v_mfma_f32_16x16x32_bf16 v[120:123], v[212:215], v[228:231], v[120:123]
    ds_read_b64_tr_b16 a[168:169], v40 offset:32768
    v_mfma_f32_16x16x32_bf16 v[72:75], v[216:219], v[224:227], v[120:123]
    buffer_load_dwordx4 v[152:155], v19, s[40:43], s14 offen offset:0 sc1
    v_mfma_f32_16x16x32_bf16 v[116:119], v[192:195], v[244:247], v[116:119]
    ds_read_b64_tr_b16 a[172:173], v41 offset:32768
    v_mfma_f32_16x16x32_bf16 v[116:119], v[196:199], v[240:243], v[116:119]
    ds_read_b64_tr_b16 a[162:163], v38 offset:34816
    v_mfma_f32_16x16x32_bf16 v[116:119], v[200:203], v[236:239], v[116:119]
    ds_read_b64_tr_b16 a[166:167], v39 offset:34816
    v_mfma_f32_16x16x32_bf16 v[116:119], v[204:207], v[232:235], v[116:119]
    buffer_load_dwordx4 v[156:159], v19, s[40:43], s14 offen offset:1024 sc1
    v_mfma_f32_16x16x32_bf16 v[116:119], v[208:211], v[228:231], v[116:119]
    ds_read_b64_tr_b16 a[170:171], v40 offset:34816
    v_mfma_f32_16x16x32_bf16 v[68:71], v[212:215], v[224:227], v[116:119]
    ds_read_b64_tr_b16 a[174:175], v41 offset:34816
    v_mfma_f32_16x16x32_bf16 v[112:115], v[192:195], v[240:243], v[112:115]
    ds_read_b64_tr_b16 a[176:177], v38 offset:49152
    v_mfma_f32_16x16x32_bf16 v[112:115], v[196:199], v[236:239], v[112:115]
    ds_read_b64_tr_b16 a[180:181], v39 offset:49152
    v_mfma_f32_16x16x32_bf16 v[112:115], v[200:203], v[232:235], v[112:115]
    ds_read_b64_tr_b16 a[184:185], v40 offset:49152
    v_mfma_f32_16x16x32_bf16 v[112:115], v[204:207], v[228:231], v[112:115]
    v_mfma_f32_16x16x32_bf16 v[64:67], v[208:211], v[224:227], v[112:115]
    s_waitcnt lgkmcnt(0)
L_c3j:
    s_barrier
    ds_read_b128 v[192:195], v10 offset:0
    ds_read_b128 v[196:199], v10 offset:1024
    ds_read_b128 v[200:203], v10 offset:2048
    ds_read_b128 v[204:207], v10 offset:3072
    s_mov_b32 s68, s71
    s_cmp_eq_u32 s25, 0
    s_cbranch_scc1 L_hok
    s_xor_b64 s[32:33], s[32:33], s[54:55]
    s_xor_b64 s[34:35], s[34:35], s[54:55]
    s_or_b64 s[32:33], s[32:33], s[34:35]
    s_xor_b64 s[36:37], s[36:37], s[54:55]
    s_or_b64 s[32:33], s[32:33], s[36:37]
    s_xor_b32 s38, s38, s19
    s_or_b32 s32, s32, s38
    s_or_b32 s32, s32, s33
    s_cbranch_scc0 L_hs_d
L_hs:
    s_mov_b32 s70, 0
L_hs_l:
    s_load_dword s32, s[30:31], s63 offset:0 glc
    s_load_dword s33, s[30:31], s63 offset:128 glc
    s_load_dword s34, s[30:31], s63 offset:256 glc
    s_load_dword s35, s[30:31], s63 offset:384 glc
    s_load_dword s36, s[30:31], s63 offset:512 glc
    s_load_dword s37, s[30:31], s63 offset:640 glc
    s_load_dword s38, s[30:31], s63 offset:768 glc
    s_add_u32 s70, s70, 1
    s_cmp_gt_u32 s70, 30000
    s_waitcnt lgkmcnt(0)
    s_cbranch_scc1 L_hs_d
    s_xor_b64 s[32:33], s[32:33], s[54:55]
    s_xor_b64 s[34:35], s[34:35], s[54:55]
    s_or_b64 s[32:33], s[32:33], s[34:35]
    s_xor_b64 s[36:37], s[36:37], s[54:55]
    s_or_b64 s[32:33], s[32:33], s[36:37]
    s_xor_b32 s38, s38, s19
    s_or_b32 s32, s32, s38
    s_or_b32 s32, s32, s33
    s_cbranch_scc1 L_hs_l
L_hs_d:
    buffer_load_dwordx4 v[128:131], v16, s[40:43], s72 offen offset:0 sc1
    buffer_load_dwordx4 v[132:135], v16, s[40:43], s72 offen offset:1024 sc1
    buffer_load_dwordx4 v[136:139], v17, s[40:43], s72 offen offset:0 sc1
    buffer_load_dwordx4 v[140:143], v17, s[40:43], s72 offen offset:1024 sc1
    buffer_load_dwordx4 v[144:147], v18, s[40:43], s72 offen offset:0 sc1
    buffer_load_dwordx4 v[148:151], v18, s[40:43], s72 offen offset:1024 sc1
    buffer_load_dwordx4 v[152:155], v19, s[40:43], s72 offen offset:0 sc1
    buffer_load_dwordx4 v[156:159], v19, s[40:43], s72 offen offset:1024 sc1
L_hok:
    v_lshlrev_b32 v208, 16, v80
    buffer_load_dwordx4 v[160:163], v20, s[40:43], s72 offen offset:0 sc1
    v_and_b32 v209, 0xffff0000, v80
    v_pk_fma_f32 v[64:65], v[208:209], s[68:69], v[64:65] op_sel_hi:[1,0,1]
    v_lshlrev_b32 v208, 16, v81
    v_and_b32 v209, 0xffff0000, v81
    v_pk_fma_f32 v[66:67], v[208:209], s[68:69], v[66:67] op_sel_hi:[1,0,1]
    v_lshlrev_b32 v208, 16, v82
    buffer_load_dwordx4 v[164:167], v20, s[40:43], s72 offen offset:1024 sc1
    v_and_b32 v209, 0xffff0000, v82
    v_pk_fma_f32 v[68:69], v[208:209], s[68:69], v[68:69] op_sel_hi:[1,0,1]
    v_lshlrev_b32 v208, 16, v83
    v_and_b32 v209, 0xffff0000, v83
    v_pk_fma_f32 v[70:71], v[208:209], s[68:69], v[70:71] op_sel_hi:[1,0,1]
    v_lshlrev_b32 v208, 16, v84
    buffer_load_dwordx4 v[168:171], v21, s[40:43], s72 offen offset:0 sc1
    v_and_b32 v209, 0xffff0000, v84
    v_pk_fma_f32 v[72:73], v[208:209], s[68:69], v[72:73] op_sel_hi:[1,0,1]
    v_lshlrev_b32 v208, 16, v85
    v_and_b32 v209, 0xffff0000, v85
    v_pk_fma_f32 v[74:75], v[208:209], s[68:69], v[74:75] op_sel_hi:[1,0,1]
    v_lshlrev_b32 v208, 16, v86
    buffer_load_dwordx4 v[172:175], v21, s[40:43], s72 offen offset:1024 sc1
    v_and_b32 v209, 0xffff0000, v86
    v_pk_fma_f32 v[76:77], v[208:209], s[68:69], v[76:77] op_sel_hi:[1,0,1]
    v_lshlrev_b32 v208, 16, v87
    v_and_b32 v209, 0xffff0000, v87
    v_pk_fma_f32 v[78:79], v[208:209], s[68:69], v[78:79] op_sel_hi:[1,0,1]
    s_waitcnt lgkmcnt(3)
    v_pk_add_f32 v[64:65], v[64:65], v[192:193]
    v_pk_add_f32 v[66:67], v[66:67], v[194:195]
    v_cvt_pk_bf16_f32 v48, v64, v65
    v_cvt_pk_bf16_f32 v49, v66, v67
    buffer_store_dwordx2 v[48:49], v14, s[40:43], s23 offen offset:0 sc1
    s_waitcnt lgkmcnt(2)
    v_pk_add_f32 v[68:69], v[68:69], v[196:197]
    v_pk_add_f32 v[70:71], v[70:71], v[198:199]
    v_cvt_pk_bf16_f32 v50, v68, v69
    v_cvt_pk_bf16_f32 v51, v70, v71
    buffer_store_dwordx2 v[50:51], v14, s[40:43], s23 offen offset:512 sc1
    s_waitcnt lgkmcnt(1)
    v_pk_add_f32 v[72:73], v[72:73], v[200:201]
    v_pk_add_f32 v[74:75], v[74:75], v[202:203]
    v_cvt_pk_bf16_f32 v52, v72, v73
    v_cvt_pk_bf16_f32 v53, v74, v75
    buffer_store_dwordx2 v[52:53], v14, s[40:43], s23 offen offset:1024 sc1
    s_waitcnt lgkmcnt(0)
    v_pk_add_f32 v[76:77], v[76:77], v[204:205]
    v_pk_add_f32 v[78:79], v[78:79], v[206:207]
    v_cvt_pk_bf16_f32 v54, v76, v77
    v_cvt_pk_bf16_f32 v55, v78, v79
    buffer_store_dwordx2 v[54:55], v14, s[40:43], s23 offen offset:1536 sc1
    buffer_load_dwordx4 v[176:179], v22, s[40:43], s72 offen offset:0 sc1
    buffer_load_dwordx4 v[180:183], v22, s[40:43], s72 offen offset:1024 sc1
    s_waitcnt vmcnt(17)
    v_mfma_f32_16x16x32_bf16 v[56:59], a[0:3], v[128:131], 0
    buffer_load_dwordx4 v[184:187], v16, s[40:43], s73 offen offset:0 sc1
    v_mfma_f32_16x16x32_bf16 v[60:63], a[4:7], v[128:131], 0
    ds_read_b64_tr_b16 a[188:189], v41 offset:49152
    s_add_u32 s58, s13, 98304
    v_mfma_f32_16x16x32_bf16 v[64:67], a[8:11], v[128:131], 0
    ds_read_b64_tr_b16 a[178:179], v38 offset:51200
    v_add_u32 v25, s58, v2
    v_mfma_f32_16x16x32_bf16 v[68:71], a[12:15], v[128:131], 0
    ds_read_b64_tr_b16 a[182:183], v39 offset:51200
    v_add_u32 v24, s13, v2
    s_waitcnt vmcnt(17)
    v_mfma_f32_16x16x32_bf16 v[56:59], a[16:19], v[132:135], v[56:59]
    buffer_load_dwordx4 v[188:191], v16, s[40:43], s73 offen offset:1024 sc1
    v_mfma_f32_16x16x32_bf16 v[60:63], a[20:23], v[132:135], v[60:63]
    ds_read_b64_tr_b16 a[186:187], v40 offset:51200
    s_sub_u32 s58, s3, 1
    v_mfma_f32_16x16x32_bf16 v[64:67], a[24:27], v[132:135], v[64:67]
    ds_read_b64_tr_b16 a[190:191], v41 offset:51200
    s_and_b32 s58, s58, 3
    v_mfma_f32_16x16x32_bf16 v[68:71], a[28:31], v[132:135], v[68:71]
    ds_read_b64_tr_b16 a[192:193], v42 offset:0
    s_lshl_b32 s58, s58, 12
    s_waitcnt vmcnt(17)
    v_mfma_f32_16x16x32_bf16 v[56:59], a[32:35], v[136:139], v[56:59]
    buffer_load_dwordx4 v[96:99], v17, s[40:43], s73 offen offset:0 sc1
    v_mfma_f32_16x16x32_bf16 v[60:63], a[36:39], v[136:139], v[60:63]
    ds_read_b64_tr_b16 a[196:197], v43 offset:0
    s_add_u32 s58, s58, 98304
    v_mfma_f32_16x16x32_bf16 v[64:67], a[40:43], v[136:139], v[64:67]
    ds_read_b64_tr_b16 a[200:201], v44 offset:0
    v_add_u32 v26, s58, v2
    v_mfma_f32_16x16x32_bf16 v[68:71], a[44:47], v[136:139], v[68:71]
    ds_read_b64_tr_b16 a[204:205], v45 offset:0
    s_sub_u32 s58, s3, 2
    s_waitcnt vmcnt(17)
    v_mfma_f32_16x16x32_bf16 v[56:59], a[48:51], v[140:143], v[56:59]
    buffer_load_dwordx4 v[100:103], v17, s[40:43], s73 offen offset:1024 sc1
    v_mfma_f32_16x16x32_bf16 v[60:63], a[52:55], v[140:143], v[60:63]
    ds_read_b64_tr_b16 a[194:195], v42 offset:2048
    s_and_b32 s58, s58, 3
    v_mfma_f32_16x16x32_bf16 v[64:67], a[56:59], v[140:143], v[64:67]
    ds_read_b64_tr_b16 a[198:199], v43 offset:2048
    s_lshl_b32 s58, s58, 12
    v_mfma_f32_16x16x32_bf16 v[68:71], a[60:63], v[140:143], v[68:71]
    ds_read_b64_tr_b16 a[202:203], v44 offset:2048
    s_add_u32 s58, s58, 114688
    s_waitcnt vmcnt(17)
    v_mfma_f32_16x16x32_bf16 v[56:59], a[64:67], v[144:147], v[56:59]
    buffer_load_dwordx4 v[104:107], v18, s[40:43], s73 offen offset:0 sc1
    v_mfma_f32_16x16x32_bf16 v[60:63], a[68:71], v[144:147], v[60:63]
    ds_read_b64_tr_b16 a[206:207], v45 offset:2048
    v_add_u32 v27, s58, v2
    v_mfma_f32_16x16x32_bf16 v[64:67], a[72:75], v[144:147], v[64:67]
    ds_read_b64_tr_b16 a[208:209], v42 offset:16384
    s_sub_u32 s58, s3, 3
    v_mfma_f32_16x16x32_bf16 v[68:71], a[76:79], v[144:147], v[68:71]
    ds_read_b64_tr_b16 a[212:213], v43 offset:16384
    s_and_b32 s58, s58, 3
    s_waitcnt vmcnt(17)
    v_mfma_f32_16x16x32_bf16 v[56:59], a[80:83], v[148:151], v[56:59]
    buffer_load_dwordx4 v[108:111], v18, s[40:43], s73 offen offset:1024 sc1
    v_mfma_f32_16x16x32_bf16 v[60:63], a[84:87], v[148:151], v[60:63]
    ds_read_b64_tr_b16 a[216:217], v44 offset:16384
    s_lshl_b32 s58, s58, 12
    v_mfma_f32_16x16x32_bf16 v[64:67], a[88:91], v[148:151], v[64:67]
    ds_read_b64_tr_b16 a[220:221], v45 offset:16384
    s_add_u32 s58, s58, 0
    v_mfma_f32_16x16x32_bf16 v[68:71], a[92:95], v[148:151], v[68:71]
    ds_read_b64_tr_b16 a[210:211], v42 offset:18432
    v_add_u32 v28, s58, v2
    s_waitcnt vmcnt(17)
    v_mfma_f32_16x16x32_bf16 v[56:59], a[96:99], v[152:155], v[56:59]
    buffer_load_dwordx4 v[112:115], v19, s[40:43], s73 offen offset:0 sc1
    v_mfma_f32_16x16x32_bf16 v[60:63], a[100:103], v[152:155], v[60:63]
    ds_read_b64_tr_b16 a[214:215], v43 offset:18432
    s_lshl_b32 s58, s3, 5
    v_mfma_f32_16x16x32_bf16 v[64:67], a[104:107], v[152:155], v[64:67]
    ds_read_b64_tr_b16 a[218:219], v44 offset:18432
    s_add_u32 s58, s58, s56
    v_mfma_f32_16x16x32_bf16 v[68:71], a[108:111], v[152:155], v[68:71]
    ds_read_b64_tr_b16 a[222:223], v45 offset:18432
    s_lshl_b32 s58, s58, 7
    s_waitcnt vmcnt(17)
    v_mfma_f32_16x16x32_bf16 v[56:59], a[112:115], v[156:159], v[56:59]
    buffer_load_dwordx4 v[116:119], v19, s[40:43], s73 offen offset:1024 sc1
    v_mfma_f32_16x16x32_bf16 v[60:63], a[116:119], v[156:159], v[60:63]
    s_add_u32 s17, s58, 425984
    s_lshl_b32 s59, s57, 1
    s_lshr_b32 s60, s56, 4
    v_mfma_f32_16x16x32_bf16 v[64:67], a[120:123], v[156:159], v[64:67]
    s_add_u32 s59, s59, s60
    s_lshl_b32 s59, s59, 2
    s_add_u32 s59, s59, s3
    v_mfma_f32_16x16x32_bf16 v[68:71], a[124:127], v[156:159], v[68:71]
    s_lshl_b32 s59, s59, 9
    s_add_u32 s27, s59, 393216
    v_and_b32 v15, 60, v46
    s_waitcnt vmcnt(17)
    v_mfma_f32_16x16x32_bf16 v[56:59], a[128:131], v[160:163], v[56:59]
    buffer_load_dwordx4 v[120:123], v20, s[40:43], s73 offen offset:0 sc1
    v_mfma_f32_16x16x32_bf16 v[60:63], a[132:135], v[160:163], v[60:63]
    v_and_b32 v12, 0x70, v34
    v_lshrrev_b32 v13, 3, v1
    v_mfma_f32_16x16x32_bf16 v[64:67], a[136:139], v[160:163], v[64:67]
    v_mul_u32_u24 v13, 4224, v13
    v_add_u32 v12, v13, v12
    s_lshl_b32 s60, s3, 5
    v_mfma_f32_16x16x32_bf16 v[68:71], a[140:143], v[160:163], v[68:71]
    v_xor_b32 v13, s60, v38
    s_sub_u32 s60, 65536, s13
    v_add_u32 v13, s60, v13
    s_waitcnt vmcnt(17)
    v_mfma_f32_16x16x32_bf16 v[56:59], a[144:147], v[164:167], v[56:59]
    buffer_load_dwordx4 v[124:127], v20, s[40:43], s73 offen offset:1024 sc1
    v_mfma_f32_16x16x32_bf16 v[60:63], a[148:151], v[164:167], v[60:63]
    s_lshl_b32 s58, s57, 2
    s_add_u32 s58, s58, s3
    s_mul_i32 s58, s58, 67584
    v_mfma_f32_16x16x32_bf16 v[64:67], a[152:155], v[164:167], v[64:67]
    s_lshl_b32 s59, s56, 7
    s_add_u32 s58, s58, s59
    s_add_u32 s58, s58, 3407872
    v_mfma_f32_16x16x32_bf16 v[68:71], a[156:159], v[164:167], v[68:71]
    s_add_u32 s59, s58, 33792
    s_lshl_b32 s60, s3, 11
    s_lshl_b32 s61, s56, 2
    s_waitcnt vmcnt(17)
    v_mfma_f32_16x16x32_bf16 v[56:59], a[160:163], v[168:171], v[56:59]
    buffer_load_dwordx4 v[88:91], v21, s[40:43], s73 offen offset:0 sc1
    v_mfma_f32_16x16x32_bf16 v[60:63], a[164:167], v[168:171], v[60:63]
    s_add_u32 s61, s61, s3
    s_lshl_b32 s62, s61, 6
    s_add_u32 s62, s62, 32768
    v_mfma_f32_16x16x32_bf16 v[64:67], a[168:171], v[168:171], v[64:67]
    s_lshl_b32 s61, s61, 14
    s_lshl_b32 s63, s57, 7
    s_add_u32 s61, s61, s63
    v_mfma_f32_16x16x32_bf16 v[68:71], a[172:175], v[168:171], v[68:71]
    s_add_u32 s63, s61, 8192
    v_and_b32 v4, 15, v1
    v_lshrrev_b32 v5, 5, v1
    s_waitcnt vmcnt(17) lgkmcnt(15)
    v_mfma_f32_16x16x32_bf16 v[56:59], a[176:179], v[172:175], v[56:59]
    buffer_load_dwordx4 v[92:95], v21, s[40:43], s73 offen offset:1024 sc1
    v_mfma_f32_16x16x32_bf16 v[60:63], a[180:183], v[172:175], v[60:63]
    v_and_b32 v7, 7, v1
    v_xor_b32 v5, v5, v7
    v_mfma_f32_16x16x32_bf16 v[64:67], a[184:187], v[172:175], v[64:67]
    s_waitcnt vmcnt(14) lgkmcnt(0)
    s_atomic_swap s19, s[30:31], s24
    v_lshlrev_b32 v5, 4, v5
    v_mfma_f32_16x16x32_bf16 v[68:71], a[188:191], v[172:175], v[68:71]
    v_lshl_add_u32 v4, v4, 7, v5
    v_bfe_u32 v5, v1, 4, 1
    s_waitcnt vmcnt(13)
    v_mfma_f32_16x16x32_bf16 v[56:59], a[192:195], v[176:179], v[56:59]
    buffer_load_dwordx4 v[192:195], v22, s[40:43], s73 offen offset:0 sc1
    v_mfma_f32_16x16x32_bf16 v[60:63], a[196:199], v[176:179], v[60:63]
    v_lshl_add_u32 v4, v5, 3, v4
    v_add_u32 v4, s60, v4
    v_mfma_f32_16x16x32_bf16 v[64:67], a[200:203], v[176:179], v[64:67]
    v_add_u32 v4, 73728, v4
    v_lshrrev_b32 v6, 3, v1
    v_mfma_f32_16x16x32_bf16 v[68:71], a[204:207], v[176:179], v[68:71]
    v_xor_b32 v5, v7, v6
    v_lshlrev_b32 v5, 4, v5
    s_waitcnt vmcnt(13)
    v_mfma_f32_16x16x32_bf16 v[56:59], a[208:211], v[180:183], v[56:59]
    buffer_load_dwordx4 v[196:199], v22, s[40:43], s73 offen offset:1024 sc1
    v_mfma_f32_16x16x32_bf16 v[60:63], a[212:215], v[180:183], v[60:63]
    v_lshl_add_u32 v5, v6, 7, v5
    v_add_u32 v5, s60, v5
    v_mfma_f32_16x16x32_bf16 v[64:67], a[216:219], v[180:183], v[64:67]
    v_add_u32 v5, 73728, v5
    v_lshlrev_b32 v6, 10, v6
    v_mfma_f32_16x16x32_bf16 v[68:71], a[220:223], v[180:183], v[68:71]
    v_lshl_add_u32 v6, v7, 4, v6
    v_xor_b32 v8, 32, v4
    v_xor_b32 v9, 64, v4
    v_xor_b32 v10, 96, v4
    v_and_b32 v11, 15, v1
    v_lshlrev_b32 v11, 10, v11
    v_lshrrev_b32_e64 v32, 4, v1
    v_lshl_add_u32 v11, v32, 3, v11
    s_lshl_b32 s45, s2, 2
    s_add_u32 s45, s45, s3
    s_waitcnt vmcnt(13)
    v_mfma_f32_16x16x32_bf16 v[72:75], a[0:3], v[184:187], 0
    buffer_load_dwordx4 v[200:203], v16, s[40:43], s74 offen offset:0 sc1
    v_mfma_f32_16x16x32_bf16 v[76:79], a[4:7], v[184:187], 0
    v_mfma_f32_16x16x32_bf16 v[80:83], a[8:11], v[184:187], 0
    v_mfma_f32_16x16x32_bf16 v[84:87], a[12:15], v[184:187], 0
    s_waitcnt vmcnt(13)
    v_mfma_f32_16x16x32_bf16 v[72:75], a[16:19], v[188:191], v[72:75]
    buffer_load_dwordx4 v[204:207], v16, s[40:43], s74 offen offset:1024 sc1
    v_mfma_f32_16x16x32_bf16 v[76:79], a[20:23], v[188:191], v[76:79]
    v_mfma_f32_16x16x32_bf16 v[80:83], a[24:27], v[188:191], v[80:83]
    ds_write_b128 v25, v[56:59] offset:0
    v_mfma_f32_16x16x32_bf16 v[84:87], a[28:31], v[188:191], v[84:87]
    s_waitcnt vmcnt(13)
    v_mfma_f32_16x16x32_bf16 v[72:75], a[32:35], v[96:99], v[72:75]
    buffer_load_dwordx4 v[208:211], v17, s[40:43], s74 offen offset:0 sc1
    v_mfma_f32_16x16x32_bf16 v[76:79], a[36:39], v[96:99], v[76:79]
    v_mfma_f32_16x16x32_bf16 v[80:83], a[40:43], v[96:99], v[80:83]
    v_mfma_f32_16x16x32_bf16 v[84:87], a[44:47], v[96:99], v[84:87]
    ds_write_b128 v25, v[60:63] offset:1024
    s_waitcnt vmcnt(13)
    v_mfma_f32_16x16x32_bf16 v[72:75], a[48:51], v[100:103], v[72:75]
    buffer_load_dwordx4 v[212:215], v17, s[40:43], s74 offen offset:1024 sc1
    v_mfma_f32_16x16x32_bf16 v[76:79], a[52:55], v[100:103], v[76:79]
    v_mfma_f32_16x16x32_bf16 v[80:83], a[56:59], v[100:103], v[80:83]
    v_mfma_f32_16x16x32_bf16 v[84:87], a[60:63], v[100:103], v[84:87]
    s_waitcnt vmcnt(13)
    v_mfma_f32_16x16x32_bf16 v[72:75], a[64:67], v[104:107], v[72:75]
    buffer_load_dwordx4 v[216:219], v18, s[40:43], s74 offen offset:0 sc1
    v_mfma_f32_16x16x32_bf16 v[76:79], a[68:71], v[104:107], v[76:79]
    ds_write_b128 v25, v[64:67] offset:2048
    v_mfma_f32_16x16x32_bf16 v[80:83], a[72:75], v[104:107], v[80:83]
    v_mfma_f32_16x16x32_bf16 v[84:87], a[76:79], v[104:107], v[84:87]
    s_waitcnt vmcnt(13)
    v_mfma_f32_16x16x32_bf16 v[72:75], a[80:83], v[108:111], v[72:75]
    buffer_load_dwordx4 v[220:223], v18, s[40:43], s74 offen offset:1024 sc1
    v_mfma_f32_16x16x32_bf16 v[76:79], a[84:87], v[108:111], v[76:79]
    ds_write_b128 v25, v[68:71] offset:3072
    v_mfma_f32_16x16x32_bf16 v[80:83], a[88:91], v[108:111], v[80:83]
    v_mfma_f32_16x16x32_bf16 v[84:87], a[92:95], v[108:111], v[84:87]
    s_waitcnt vmcnt(13)
    v_mfma_f32_16x16x32_bf16 v[72:75], a[96:99], v[112:115], v[72:75]
    buffer_load_dwordx4 v[224:227], v19, s[40:43], s74 offen offset:0 sc1
    v_mfma_f32_16x16x32_bf16 v[76:79], a[100:103], v[112:115], v[76:79]
    v_mfma_f32_16x16x32_bf16 v[80:83], a[104:107], v[112:115], v[80:83]
    v_mfma_f32_16x16x32_bf16 v[84:87], a[108:111], v[112:115], v[84:87]
    s_waitcnt vmcnt(13)
    v_mfma_f32_16x16x32_bf16 v[72:75], a[112:115], v[116:119], v[72:75]
    buffer_load_dwordx4 v[228:231], v19, s[40:43], s74 offen offset:1024 sc1
    v_mfma_f32_16x16x32_bf16 v[76:79], a[116:119], v[116:119], v[76:79]
    v_mfma_f32_16x16x32_bf16 v[80:83], a[120:123], v[116:119], v[80:83]
    v_mfma_f32_16x16x32_bf16 v[84:87], a[124:127], v[116:119], v[84:87]
    s_waitcnt vmcnt(13)
    v_mfma_f32_16x16x32_bf16 v[72:75], a[128:131], v[120:123], v[72:75]
    buffer_load_dwordx4 v[232:235], v20, s[40:43], s74 offen offset:0 sc1
    v_mfma_f32_16x16x32_bf16 v[76:79], a[132:135], v[120:123], v[76:79]
    v_mfma_f32_16x16x32_bf16 v[80:83], a[136:139], v[120:123], v[80:83]
L_pg7:
    s_cbranch_execz L_pgback
    s_nop 0
    v_mfma_f32_16x16x32_bf16 v[84:87], a[140:143], v[120:123], v[84:87]
    s_waitcnt vmcnt(13)
    v_mfma_f32_16x16x32_bf16 v[72:75], a[144:147], v[124:127], v[72:75]
    buffer_load_dwordx4 v[236:239], v20, s[40:43], s74 offen offset:1024 sc1
    v_mfma_f32_16x16x32_bf16 v[76:79], a[148:151], v[124:127], v[76:79]
    v_mfma_f32_16x16x32_bf16 v[80:83], a[152:155], v[124:127], v[80:83]
    v_mfma_f32_16x16x32_bf16 v[84:87], a[156:159], v[124:127], v[84:87]
    s_waitcnt vmcnt(13)
    v_mfma_f32_16x16x32_bf16 v[72:75], a[160:163], v[88:91], v[72:75]
    buffer_load_dwordx4 v[240:243], v21, s[40:43], s74 offen offset:0 sc1
    v_mfma_f32_16x16x32_bf16 v[76:79], a[164:167], v[88:91], v[76:79]
    v_mfma_f32_16x16x32_bf16 v[80:83], a[168:171], v[88:91], v[80:83]
    v_mfma_f32_16x16x32_bf16 v[84:87], a[172:175], v[88:91], v[84:87]
    s_waitcnt vmcnt(13)
    v_mfma_f32_16x16x32_bf16 v[72:75], a[176:179], v[92:95], v[72:75]
    buffer_load_dwordx4 v[244:247], v21, s[40:43], s74 offen offset:1024 sc1
    v_mfma_f32_16x16x32_bf16 v[76:79], a[180:183], v[92:95], v[76:79]
    v_mfma_f32_16x16x32_bf16 v[80:83], a[184:187], v[92:95], v[80:83]
    v_mfma_f32_16x16x32_bf16 v[84:87], a[188:191], v[92:95], v[84:87]
    s_waitcnt vmcnt(13)
    v_mfma_f32_16x16x32_bf16 v[72:75], a[192:195], v[192:195], v[72:75]
    buffer_load_dwordx4 v[248:251], v22, s[40:43], s74 offen offset:0 sc1
    v_mfma_f32_16x16x32_bf16 v[76:79], a[196:199], v[192:195], v[76:79]
    v_mfma_f32_16x16x32_bf16 v[80:83], a[200:203], v[192:195], v[80:83]
    v_mfma_f32_16x16x32_bf16 v[84:87], a[204:207], v[192:195], v[84:87]
    s_waitcnt vmcnt(13)
    v_mfma_f32_16x16x32_bf16 v[72:75], a[208:211], v[196:199], v[72:75]
    buffer_load_dwordx4 v[252:255], v22, s[40:43], s74 offen offset:1024 sc1
    v_mfma_f32_16x16x32_bf16 v[76:79], a[212:215], v[196:199], v[76:79]
    v_mfma_f32_16x16x32_bf16 v[80:83], a[216:219], v[196:199], v[80:83]
    v_mfma_f32_16x16x32_bf16 v[84:87], a[220:223], v[196:199], v[84:87]
    s_waitcnt vmcnt(13)
    v_mfma_f32_16x16x32_bf16 v[56:59], a[0:3], v[200:203], 0
    buffer_load_dwordx4 v[128:131], v16, s[40:43], s75 offen offset:0 sc1
    v_mfma_f32_16x16x32_bf16 v[60:63], a[4:7], v[200:203], 0
    v_mfma_f32_16x16x32_bf16 v[64:67], a[8:11], v[200:203], 0
    v_mfma_f32_16x16x32_bf16 v[68:71], a[12:15], v[200:203], 0
    s_waitcnt vmcnt(13)
    v_mfma_f32_16x16x32_bf16 v[56:59], a[16:19], v[204:207], v[56:59]
    buffer_load_dwordx4 v[132:135], v16, s[40:43], s75 offen offset:1024 sc1
    v_mfma_f32_16x16x32_bf16 v[60:63], a[20:23], v[204:207], v[60:63]
    v_mfma_f32_16x16x32_bf16 v[64:67], a[24:27], v[204:207], v[64:67]
    ds_write_b128 v25, v[72:75] offset:16384
    v_mfma_f32_16x16x32_bf16 v[68:71], a[28:31], v[204:207], v[68:71]
    s_waitcnt vmcnt(13)
    v_mfma_f32_16x16x32_bf16 v[56:59], a[32:35], v[208:211], v[56:59]
    buffer_load_dwordx4 v[136:139], v17, s[40:43], s75 offen offset:0 sc1
    v_mfma_f32_16x16x32_bf16 v[60:63], a[36:39], v[208:211], v[60:63]
    v_mfma_f32_16x16x32_bf16 v[64:67], a[40:43], v[208:211], v[64:67]
    v_mfma_f32_16x16x32_bf16 v[68:71], a[44:47], v[208:211], v[68:71]
    ds_write_b128 v25, v[76:79] offset:17408
    s_waitcnt vmcnt(13)
    v_mfma_f32_16x16x32_bf16 v[56:59], a[48:51], v[212:215], v[56:59]
    buffer_load_dwordx4 v[140:143], v17, s[40:43], s75 offen offset:1024 sc1
    v_mfma_f32_16x16x32_bf16 v[60:63], a[52:55], v[212:215], v[60:63]
    v_mfma_f32_16x16x32_bf16 v[64:67], a[56:59], v[212:215], v[64:67]
    v_mfma_f32_16x16x32_bf16 v[68:71], a[60:63], v[212:215], v[68:71]
    s_waitcnt vmcnt(13)
    v_mfma_f32_16x16x32_bf16 v[56:59], a[64:67], v[216:219], v[56:59]
    buffer_load_dwordx4 v[144:147], v18, s[40:43], s75 offen offset:0 sc1
    v_mfma_f32_16x16x32_bf16 v[60:63], a[68:71], v[216:219], v[60:63]
    ds_write_b128 v25, v[80:83] offset:18432
    v_mfma_f32_16x16x32_bf16 v[64:67], a[72:75], v[216:219], v[64:67]
    v_mfma_f32_16x16x32_bf16 v[68:71], a[76:79], v[216:219], v[68:71]
    s_waitcnt vmcnt(13)
    v_mfma_f32_16x16x32_bf16 v[56:59], a[80:83], v[220:223], v[56:59]
    buffer_load_dwordx4 v[148:151], v18, s[40:43], s75 offen offset:1024 sc1
    v_mfma_f32_16x16x32_bf16 v[60:63], a[84:87], v[220:223], v[60:63]
    ds_write_b128 v25, v[84:87] offset:19456
    v_mfma_f32_16x16x32_bf16 v[64:67], a[88:91], v[220:223], v[64:67]
    s_load_dwordx4 s[4:7], s[30:31], s27 offset:0 glc
    s_load_dwordx4 s[8:11], s[30:31], s27 offset:128 glc
    s_load_dwordx4 s[32:35], s[30:31], s27 offset:256 glc
    v_mfma_f32_16x16x32_bf16 v[68:71], a[92:95], v[220:223], v[68:71]
    s_load_dwordx4 s[36:39], s[30:31], s27 offset:384 glc
    s_load_dword s44, s[30:31], s17 offset:0 glc
    s_waitcnt vmcnt(13)
    v_mfma_f32_16x16x32_bf16 v[56:59], a[96:99], v[224:227], v[56:59]
    buffer_load_dwordx4 v[152:155], v19, s[40:43], s75 offen offset:0 sc1
    v_mfma_f32_16x16x32_bf16 v[60:63], a[100:103], v[224:227], v[60:63]
    v_mfma_f32_16x16x32_bf16 v[64:67], a[104:107], v[224:227], v[64:67]
    v_mfma_f32_16x16x32_bf16 v[68:71], a[108:111], v[224:227], v[68:71]
    s_waitcnt vmcnt(13)
    v_mfma_f32_16x16x32_bf16 v[56:59], a[112:115], v[228:231], v[56:59]
    buffer_load_dwordx4 v[156:159], v19, s[40:43], s75 offen offset:1024 sc1
    v_mfma_f32_16x16x32_bf16 v[60:63], a[116:119], v[228:231], v[60:63]
    v_mfma_f32_16x16x32_bf16 v[64:67], a[120:123], v[228:231], v[64:67]
    v_mfma_f32_16x16x32_bf16 v[68:71], a[124:127], v[228:231], v[68:71]
    s_waitcnt vmcnt(13)
    v_mfma_f32_16x16x32_bf16 v[56:59], a[128:131], v[232:235], v[56:59]
    buffer_load_dwordx4 v[160:163], v20, s[40:43], s75 offen offset:0 sc1
    v_mfma_f32_16x16x32_bf16 v[60:63], a[132:135], v[232:235], v[60:63]
    v_mfma_f32_16x16x32_bf16 v[64:67], a[136:139], v[232:235], v[64:67]
    v_mfma_f32_16x16x32_bf16 v[68:71], a[140:143], v[232:235], v[68:71]
    s_waitcnt vmcnt(13)
    v_mfma_f32_16x16x32_bf16 v[56:59], a[144:147], v[236:239], v[56:59]
    buffer_load_dwordx4 v[164:167], v20, s[40:43], s75 offen offset:1024 sc1
    v_mfma_f32_16x16x32_bf16 v[60:63], a[148:151], v[236:239], v[60:63]
    v_mfma_f32_16x16x32_bf16 v[64:67], a[152:155], v[236:239], v[64:67]
    v_mfma_f32_16x16x32_bf16 v[68:71], a[156:159], v[236:239], v[68:71]
    s_waitcnt vmcnt(13)
    v_mfma_f32_16x16x32_bf16 v[56:59], a[160:163], v[240:243], v[56:59]
    buffer_load_dwordx4 v[168:171], v21, s[40:43], s75 offen offset:0 sc1
    v_mfma_f32_16x16x32_bf16 v[60:63], a[164:167], v[240:243], v[60:63]
    v_mfma_f32_16x16x32_bf16 v[64:67], a[168:171], v[240:243], v[64:67]
    v_mfma_f32_16x16x32_bf16 v[68:71], a[172:175], v[240:243], v[68:71]
    s_waitcnt vmcnt(13)
    v_mfma_f32_16x16x32_bf16 v[56:59], a[176:179], v[244:247], v[56:59]
    buffer_load_dwordx4 v[172:175], v21, s[40:43], s75 offen offset:1024 sc1
    v_mfma_f32_16x16x32_bf16 v[60:63], a[180:183], v[244:247], v[60:63]
    v_mfma_f32_16x16x32_bf16 v[64:67], a[184:187], v[244:247], v[64:67]
    v_mfma_f32_16x16x32_bf16 v[68:71], a[188:191], v[244:247], v[68:71]
    s_waitcnt vmcnt(13)
    v_mfma_f32_16x16x32_bf16 v[56:59], a[192:195], v[248:251], v[56:59]
    buffer_load_dwordx4 v[176:179], v22, s[40:43], s75 offen offset:0 sc1
    v_mfma_f32_16x16x32_bf16 v[60:63], a[196:199], v[248:251], v[60:63]
    v_mfma_f32_16x16x32_bf16 v[64:67], a[200:203], v[248:251], v[64:67]
    v_mfma_f32_16x16x32_bf16 v[68:71], a[204:207], v[248:251], v[68:71]
    s_waitcnt vmcnt(13)
    v_mfma_f32_16x16x32_bf16 v[56:59], a[208:211], v[252:255], v[56:59]
    buffer_load_dwordx4 v[180:183], v22, s[40:43], s75 offen offset:1024 sc1
    v_mfma_f32_16x16x32_bf16 v[60:63], a[212:215], v[252:255], v[60:63]
    v_mfma_f32_16x16x32_bf16 v[64:67], a[216:219], v[252:255], v[64:67]
    v_mfma_f32_16x16x32_bf16 v[68:71], a[220:223], v[252:255], v[68:71]
    s_waitcnt vmcnt(13)
    v_mfma_f32_16x16x32_bf16 v[72:75], a[0:3], v[128:131], 0
    v_mfma_f32_16x16x32_bf16 v[76:79], a[4:7], v[128:131], 0
    v_mfma_f32_16x16x32_bf16 v[80:83], a[8:11], v[128:131], 0
    v_mfma_f32_16x16x32_bf16 v[84:87], a[12:15], v[128:131], 0
    s_waitcnt vmcnt(12)
    v_mfma_f32_16x16x32_bf16 v[72:75], a[16:19], v[132:135], v[72:75]
    s_waitcnt lgkmcnt(0)
    s_xor_b64 s[4:5], s[4:5], s[54:55]
    s_xor_b64 s[6:7], s[6:7], s[54:55]
    v_mfma_f32_16x16x32_bf16 v[76:79], a[20:23], v[132:135], v[76:79]
    s_or_b64 s[4:5], s[4:5], s[6:7]
    s_xor_b64 s[8:9], s[8:9], s[54:55]
    s_or_b64 s[4:5], s[4:5], s[8:9]
    v_mfma_f32_16x16x32_bf16 v[80:83], a[24:27], v[132:135], v[80:83]
    ds_write_b128 v24, v[56:59] offset:0
    v_mfma_f32_16x16x32_bf16 v[84:87], a[28:31], v[132:135], v[84:87]
    ds_write_b128 v24, v[60:63] offset:1024
    s_waitcnt vmcnt(11)
    v_mfma_f32_16x16x32_bf16 v[72:75], a[32:35], v[136:139], v[72:75]
    s_xor_b64 s[10:11], s[10:11], s[54:55]
    s_or_b64 s[4:5], s[4:5], s[10:11]
    s_xor_b64 s[32:33], s[32:33], s[54:55]
    v_mfma_f32_16x16x32_bf16 v[76:79], a[36:39], v[136:139], v[76:79]
    ds_write_b128 v24, v[64:67] offset:2048
    v_mfma_f32_16x16x32_bf16 v[80:83], a[40:43], v[136:139], v[80:83]
    s_or_b64 s[4:5], s[4:5], s[32:33]
    s_xor_b64 s[34:35], s[34:35], s[54:55]
    s_or_b64 s[4:5], s[4:5], s[34:35]
    v_mfma_f32_16x16x32_bf16 v[84:87], a[44:47], v[136:139], v[84:87]
    ds_write_b128 v24, v[68:71] offset:3072
    s_waitcnt vmcnt(10)
    v_mfma_f32_16x16x32_bf16 v[72:75], a[48:51], v[140:143], v[72:75]
    s_xor_b64 s[36:37], s[36:37], s[54:55]
    s_or_b64 s[4:5], s[4:5], s[36:37]
    s_xor_b64 s[38:39], s[38:39], s[54:55]
    v_mfma_f32_16x16x32_bf16 v[76:79], a[52:55], v[140:143], v[76:79]
    s_or_b64 s[4:5], s[4:5], s[38:39]
    s_xor_b32 s44, s44, s19
    s_or_b32 s4, s4, s44
    v_mfma_f32_16x16x32_bf16 v[80:83], a[56:59], v[140:143], v[80:83]
    v_mfma_f32_16x16x32_bf16 v[84:87], a[60:63], v[140:143], v[84:87]
    s_waitcnt lgkmcnt(0)
    s_or_b32 s4, s4, s5
    s_cselect_b32 s25, 1, 0
    s_cbranch_scc1 L_a1
    s_add_u32 m0, s60, 65536
    s_nop 0
    buffer_load_dwordx4 v12, s[40:43], s58 offen sc1 lds
    s_add_u32 m0, s60, 66560
    s_nop 0
    buffer_load_dwordx4 v12, s[40:43], s59 offen sc1 lds
    buffer_load_dword v30, v15, s[40:43], s62 offen sc1
    s_branch L_a1j
L_a1:
    s_load_dwordx4 s[4:7], s[30:31], s27 offset:0 glc
    s_load_dwordx4 s[8:11], s[30:31], s27 offset:128 glc
    s_load_dwordx4 s[32:35], s[30:31], s27 offset:256 glc
    s_load_dwordx4 s[36:39], s[30:31], s27 offset:384 glc
    s_load_dword s44, s[30:31], s17 offset:0 glc
L_a1j:
    s_barrier
    s_waitcnt vmcnt(9)
    v_mfma_f32_16x16x32_bf16 v[72:75], a[64:67], v[144:147], v[72:75]
    ds_read_b128 v[56:59], v26 offset:0
    v_mfma_f32_16x16x32_bf16 v[76:79], a[68:71], v[144:147], v[76:79]
    ds_read_b128 v[192:195], v27 offset:0
    v_mfma_f32_16x16x32_bf16 v[80:83], a[72:75], v[144:147], v[80:83]
    ds_read_b128 v[208:211], v28 offset:0
    v_mfma_f32_16x16x32_bf16 v[84:87], a[76:79], v[144:147], v[84:87]
    ds_read_b128 v[60:63], v26 offset:1024
    s_waitcnt vmcnt(8)
    v_mfma_f32_16x16x32_bf16 v[72:75], a[80:83], v[148:151], v[72:75]
    ds_read_b128 v[196:199], v27 offset:1024
    v_mfma_f32_16x16x32_bf16 v[76:79], a[84:87], v[148:151], v[76:79]
    ds_read_b128 v[212:215], v28 offset:1024
    v_mfma_f32_16x16x32_bf16 v[80:83], a[88:91], v[148:151], v[80:83]
    ds_read_b128 v[64:67], v26 offset:2048
    v_mfma_f32_16x16x32_bf16 v[84:87], a[92:95], v[148:151], v[84:87]
    ds_read_b128 v[200:203], v27 offset:2048
    s_waitcnt vmcnt(7)
    v_mfma_f32_16x16x32_bf16 v[72:75], a[96:99], v[152:155], v[72:75]
    ds_read_b128 v[216:219], v28 offset:2048
    v_mfma_f32_16x16x32_bf16 v[76:79], a[100:103], v[152:155], v[76:79]
    ds_read_b128 v[68:71], v26 offset:3072
    v_mfma_f32_16x16x32_bf16 v[80:83], a[104:107], v[152:155], v[80:83]
    ds_read_b128 v[204:207], v27 offset:3072
    v_mfma_f32_16x16x32_bf16 v[84:87], a[108:111], v[152:155], v[84:87]
    ds_read_b128 v[220:223], v28 offset:3072
    s_waitcnt vmcnt(6)
    v_mfma_f32_16x16x32_bf16 v[72:75], a[112:115], v[156:159], v[72:75]
    v_mfma_f32_16x16x32_bf16 v[76:79], a[116:119], v[156:159], v[76:79]
    s_cmp_lg_u32 s45, 1020
    s_cbranch_scc1 L_ne
    v_and_b32 v33, 31, v1
    v_lshlrev_b32 v33, 7, v33
    v_add_u32 v33, 393216, v33
    buffer_load_dwordx4 v[248:251], v33, s[40:43], 0 offen sc1
L_ne:
    v_mfma_f32_16x16x32_bf16 v[80:83], a[120:123], v[156:159], v[80:83]
    v_mfma_f32_16x16x32_bf16 v[84:87], a[124:127], v[156:159], v[84:87]
    s_waitcnt vmcnt(5)
    v_mfma_f32_16x16x32_bf16 v[72:75], a[128:131], v[160:163], v[72:75]
    v_mfma_f32_16x16x32_bf16 v[76:79], a[132:135], v[160:163], v[76:79]
    s_waitcnt lgkmcnt(0)
    v_mfma_f32_16x16x32_bf16 v[80:83], a[136:139], v[160:163], v[80:83]
    s_cmp_eq_u32 s25, 0
    s_cbranch_scc1 L_a2
    s_waitcnt lgkmcnt(0)
    s_xor_b64 s[4:5], s[4:5], s[54:55]
    s_xor_b64 s[6:7], s[6:7], s[54:55]
    s_or_b64 s[4:5], s[4:5], s[6:7]
    s_xor_b64 s[8:9], s[8:9], s[54:55]
    s_or_b64 s[4:5], s[4:5], s[8:9]
    s_xor_b64 s[10:11], s[10:11], s[54:55]
    s_or_b64 s[4:5], s[4:5], s[10:11]
    s_xor_b64 s[32:33], s[32:33], s[54:55]
    s_or_b64 s[4:5], s[4:5], s[32:33]
    s_xor_b64 s[34:35], s[34:35], s[54:55]
    s_or_b64 s[4:5], s[4:5], s[34:35]
    s_xor_b64 s[36:37], s[36:37], s[54:55]
    s_or_b64 s[4:5], s[4:5], s[36:37]
    s_xor_b64 s[38:39], s[38:39], s[54:55]
    s_or_b64 s[4:5], s[4:5], s[38:39]
    s_xor_b32 s44, s44, s19
    s_or_b32 s4, s4, s44
    s_or_b32 s4, s4, s5
    s_cbranch_scc1 L_a2
    s_mov_b32 s25, 0
    s_add_u32 m0, s60, 65536
    s_nop 0
    buffer_load_dwordx4 v12, s[40:43], s58 offen sc1 lds
    s_add_u32 m0, s60, 66560
    s_nop 0
    buffer_load_dwordx4 v12, s[40:43], s59 offen sc1 lds
    buffer_load_dword v30, v15, s[40:43], s62 offen sc1
L_a2:
    v_mfma_f32_16x16x32_bf16 v[84:87], a[140:143], v[160:163], v[84:87]
    v_add_f32 v56, v56, v192
    v_add_f32 v57, v57, v193
    s_waitcnt vmcnt(4)
    v_mfma_f32_16x16x32_bf16 v[72:75], a[144:147], v[164:167], v[72:75]
    v_add_f32 v58, v58, v194
    v_add_f32 v59, v59, v195
    v_mfma_f32_16x16x32_bf16 v[76:79], a[148:151], v[164:167], v[76:79]
    v_add_f32 v60, v60, v196
    v_add_f32 v61, v61, v197
    v_mfma_f32_16x16x32_bf16 v[80:83], a[152:155], v[164:167], v[80:83]
    v_add_f32 v62, v62, v198
    v_add_f32 v63, v63, v199
    v_mfma_f32_16x16x32_bf16 v[84:87], a[156:159], v[164:167], v[84:87]
    v_add_f32 v64, v64, v200
    v_add_f32 v65, v65, v201
    s_waitcnt vmcnt(3)
    v_mfma_f32_16x16x32_bf16 v[72:75], a[160:163], v[168:171], v[72:75]
    v_add_f32 v66, v66, v202
    v_add_f32 v67, v67, v203
    v_mfma_f32_16x16x32_bf16 v[76:79], a[164:167], v[168:171], v[76:79]
    v_add_f32 v68, v68, v204
    v_add_f32 v69, v69, v205
    v_mfma_f32_16x16x32_bf16 v[80:83], a[168:171], v[168:171], v[80:83]
    v_add_f32 v70, v70, v206
    v_add_f32 v71, v71, v207
    v_mfma_f32_16x16x32_bf16 v[84:87], a[172:175], v[168:171], v[84:87]
    v_add_f32 v56, v56, v208
    v_add_f32 v57, v57, v209
    s_waitcnt vmcnt(2)
    v_mfma_f32_16x16x32_bf16 v[72:75], a[176:179], v[172:175], v[72:75]
    v_add_f32 v58, v58, v210
    v_add_f32 v59, v59, v211
    v_mfma_f32_16x16x32_bf16 v[76:79], a[180:183], v[172:175], v[76:79]
    v_add_f32 v60, v60, v212
    v_add_f32 v61, v61, v213
    v_mfma_f32_16x16x32_bf16 v[80:83], a[184:187], v[172:175], v[80:83]
    v_add_f32 v62, v62, v214
    v_add_f32 v63, v63, v215
    v_mfma_f32_16x16x32_bf16 v[84:87], a[188:191], v[172:175], v[84:87]
    v_add_f32 v64, v64, v216
    v_add_f32 v65, v65, v217
    s_waitcnt vmcnt(1)
    v_mfma_f32_16x16x32_bf16 v[72:75], a[192:195], v[176:179], v[72:75]
    v_add_f32 v66, v66, v218
    v_add_f32 v67, v67, v219
    v_mfma_f32_16x16x32_bf16 v[76:79], a[196:199], v[176:179], v[76:79]
    v_add_f32 v68, v68, v220
    v_add_f32 v69, v69, v221
    v_mfma_f32_16x16x32_bf16 v[80:83], a[200:203], v[176:179], v[80:83]
    v_add_f32 v70, v70, v222
    v_add_f32 v71, v71, v223
    v_mfma_f32_16x16x32_bf16 v[84:87], a[204:207], v[176:179], v[84:87]
    s_cmp_lg_u32 s25, 0
    s_cbranch_scc0 L_lateb
L_late:
    s_mov_b32 s70, 0
L_late_l:
    s_load_dwordx4 s[4:7], s[30:31], s27 offset:0 glc
    s_load_dwordx4 s[8:11], s[30:31], s27 offset:128 glc
    s_load_dwordx4 s[32:35], s[30:31], s27 offset:256 glc
    s_load_dwordx4 s[36:39], s[30:31], s27 offset:384 glc
    s_load_dword s44, s[30:31], s17 offset:0 glc
    s_add_u32 s70, s70, 1
    s_cmp_gt_u32 s70, 30000
    s_waitcnt lgkmcnt(0)
    s_cbranch_scc1 L_late_d
    s_xor_b64 s[4:5], s[4:5], s[54:55]
    s_xor_b64 s[6:7], s[6:7], s[54:55]
    s_or_b64 s[4:5], s[4:5], s[6:7]
    s_xor_b64 s[8:9], s[8:9], s[54:55]
    s_or_b64 s[4:5], s[4:5], s[8:9]
    s_xor_b64 s[10:11], s[10:11], s[54:55]
    s_or_b64 s[4:5], s[4:5], s[10:11]
    s_xor_b64 s[32:33], s[32:33], s[54:55]
    s_or_b64 s[4:5], s[4:5], s[32:33]
    s_xor_b64 s[34:35], s[34:35], s[54:55]
    s_or_b64 s[4:5], s[4:5], s[34:35]
    s_xor_b64 s[36:37], s[36:37], s[54:55]
    s_or_b64 s[4:5], s[4:5], s[36:37]
    s_xor_b64 s[38:39], s[38:39], s[54:55]
    s_or_b64 s[4:5], s[4:5], s[38:39]
    s_xor_b32 s44, s44, s19
    s_or_b32 s4, s4, s44
    s_or_b32 s4, s4, s5
    s_cbranch_scc1 L_late_l
L_late_d:
    s_add_u32 m0, s60, 65536
    s_nop 0
    buffer_load_dwordx4 v12, s[40:43], s58 offen sc1 lds
    s_add_u32 m0, s60, 66560
    s_nop 0
    buffer_load_dwordx4 v12, s[40:43], s59 offen sc1 lds
    buffer_load_dword v30, v15, s[40:43], s62 offen sc1
L_lateb:
    s_waitcnt vmcnt(0)
    s_barrier
    v_mfma_f32_16x16x32_bf16 v[72:75], a[208:211], v[180:183], v[72:75]
    ds_read_b64_tr_b16 v[48:49], v13 offset:0
    v_mfma_f32_16x16x32_bf16 v[76:79], a[212:215], v[180:183], v[76:79]
    ds_read_b64_tr_b16 v[50:51], v13 offset:2048
    v_mfma_f32_16x16x32_bf16 v[80:83], a[216:219], v[180:183], v[80:83]
    ds_read_b64_tr_b16 v[52:53], v13 offset:4096
    v_mfma_f32_16x16x32_bf16 v[84:87], a[220:223], v[180:183], v[84:87]
    ds_read_b64_tr_b16 v[54:55], v13 offset:6144
    v_sub_f32 v31, 1.0, v30
    s_waitcnt lgkmcnt(3)
    v_lshlrev_b32 v224, 16, v48
    v_and_b32 v225, 0xffff0000, v48
    v_lshlrev_b32 v226, 16, v49
    v_and_b32 v227, 0xffff0000, v49
    v_pk_mul_f32 v[224:225], v[224:225], v[30:31] op_sel_hi:[1,0]
    v_pk_add_f32 v[72:73], v[72:73], v[56:57]
    v_pk_fma_f32 v[72:73], v[72:73], v[30:31], v[224:225] op_sel:[0,1,0] op_sel_hi:[1,1,1]
    v_pk_mul_f32 v[226:227], v[226:227], v[30:31] op_sel_hi:[1,0]
    v_pk_add_f32 v[74:75], v[74:75], v[58:59]
    v_pk_fma_f32 v[74:75], v[74:75], v[30:31], v[226:227] op_sel:[0,1,0] op_sel_hi:[1,1,1]
    v_cvt_pk_bf16_f32 v48, v72, v73
    v_cvt_pk_bf16_f32 v49, v74, v75
    ds_write_b64 v4, v[48:49]
    s_waitcnt lgkmcnt(3)
    v_lshlrev_b32 v228, 16, v50
    v_and_b32 v229, 0xffff0000, v50
    v_lshlrev_b32_e64 v230, 16, v51
    v_and_b32 v231, 0xffff0000, v51
    v_pk_mul_f32 v[228:229], v[228:229], v[30:31] op_sel_hi:[1,0]
    v_pk_add_f32 v[76:77], v[76:77], v[60:61]
    v_pk_fma_f32 v[76:77], v[76:77], v[30:31], v[228:229] op_sel:[0,1,0] op_sel_hi:[1,1,1]
    v_pk_mul_f32 v[230:231], v[230:231], v[30:31] op_sel_hi:[1,0]
    v_pk_add_f32 v[78:79], v[78:79], v[62:63]
    v_pk_fma_f32 v[78:79], v[78:79], v[30:31], v[230:231] op_sel:[0,1,0] op_sel_hi:[1,1,1]
    v_cvt_pk_bf16_f32 v50, v76, v77
    v_cvt_pk_bf16_f32 v51, v78, v79
    ds_write_b64 v8, v[50:51]
    s_waitcnt lgkmcnt(3)
    v_lshlrev_b32 v232, 16, v52
    v_and_b32 v233, 0xffff0000, v52
    v_lshlrev_b32_e64 v234, 16, v53
    v_and_b32 v235, 0xffff0000, v53
    v_pk_mul_f32 v[232:233], v[232:233], v[30:31] op_sel_hi:[1,0]
    v_pk_add_f32 v[80:81], v[80:81], v[64:65]
    v_pk_fma_f32 v[80:81], v[80:81], v[30:31], v[232:233] op_sel:[0,1,0] op_sel_hi:[1,1,1]
    v_pk_mul_f32 v[234:235], v[234:235], v[30:31] op_sel_hi:[1,0]
    v_pk_add_f32 v[82:83], v[82:83], v[66:67]
    v_pk_fma_f32 v[82:83], v[82:83], v[30:31], v[234:235] op_sel:[0,1,0] op_sel_hi:[1,1,1]
    v_cvt_pk_bf16_f32 v52, v80, v81
    v_cvt_pk_bf16_f32 v53, v82, v83
    ds_write_b64 v9, v[52:53]
    s_waitcnt lgkmcnt(3)
    v_lshlrev_b32 v236, 16, v54
    v_and_b32 v237, 0xffff0000, v54
    v_lshlrev_b32_e64 v238, 16, v55
    v_and_b32 v239, 0xffff0000, v55
    v_pk_mul_f32 v[236:237], v[236:237], v[30:31] op_sel_hi:[1,0]
    v_pk_add_f32 v[84:85], v[84:85], v[68:69]
    v_pk_fma_f32 v[84:85], v[84:85], v[30:31], v[236:237] op_sel:[0,1,0] op_sel_hi:[1,1,1]
    v_pk_mul_f32 v[238:239], v[238:239], v[30:31] op_sel_hi:[1,0]
    v_pk_add_f32 v[86:87], v[86:87], v[70:71]
    v_pk_fma_f32 v[86:87], v[86:87], v[30:31], v[238:239] op_sel:[0,1,0] op_sel_hi:[1,1,1]
    v_cvt_pk_bf16_f32 v54, v84, v85
    v_cvt_pk_bf16_f32 v55, v86, v87
    ds_write_b64 v10, v[54:55]
    ds_read_b128 v[240:243], v5 offset:0
    ds_read_b128 v[244:247], v5 offset:1024
    s_waitcnt lgkmcnt(1)
    buffer_store_dwordx4 v[240:243], v6, s[48:51], s61 offen sc1
    s_waitcnt lgkmcnt(0)
    buffer_store_dwordx4 v[244:247], v6, s[48:51], s63 offen sc1
    s_cmp_lg_u32 s45, 1020
    s_cbranch_scc1 L_nb
    s_mov_b32 s70, 0
L_eb:
    v_xor_b32 v248, s19, v248
    v_xor_b32 v249, s19, v249
    v_xor_b32 v250, s19, v250
    v_xor_b32 v251, s19, v251
    v_or_b32 v248, v248, v249
    v_or3_b32 v248, v248, v250, v251
    v_cmp_ne_u32 vcc, 0, v248
    s_add_u32 s70, s70, 1
    s_cmp_gt_u32 s70, 30000
    s_cbranch_scc1 L_ebd
    s_cbranch_vccz L_ebd
    buffer_load_dwordx4 v[248:251], v33, s[40:43], 0 offen sc1
    s_waitcnt vmcnt(0)
    s_branch L_eb
L_ebd:
    s_atomic_swap s19, s[30:31], 0
L_nb:
L_end:
    s_endpgm
L_aux:
    s_lshr_b32 s76, s3, 1
    s_and_b32 s77, s3, 1
    s_cmp_eq_u32 s77, 0
    s_cselect_b64 s[36:37], s[20:21], s[22:23]
    s_mov_b32 s38, 0x1c0000
    s_mov_b32 s39, 0x20000
    s_lshr_b32 s55, s53, 2
    s_and_b32 s58, s55, 3
    s_add_u32 s58, s58, 1
    s_and_b32 s58, s58, 4
    s_xor_b32 s57, s55, s58
    s_and_b32 s59, s52, 1
    s_mul_i32 s59, s59, 7
    s_add_u32 s55, s55, s59
    s_lshl_b32 s56, s52, 2
    s_and_b32 s58, s53, 3
    s_add_u32 s56, s56, s58
    s_mov_b32 s40, s30
    s_mov_b32 s41, s31
    s_mov_b32 s42, 0xe00000
    s_mov_b32 s43, 0x20000
    s_mov_b32 s44, s24
    s_mov_b32 s45, s25
    s_mov_b32 s46, 0x1c0000
    s_mov_b32 s47, 0x20000
    s_mov_b32 s48, s28
    s_mov_b32 s49, s29
    s_mov_b32 s50, 0x200000
    s_mov_b32 s51, 0x20000
    s_sub_u32 s58, s2, 224
    s_lshl_b32 s65, s58, 2
    s_add_u32 s65, s65, s3
    s_lshl_b32 s65, s65, 14
    s_lshl_b32 s67, s3, 11
    v_and_b32 v4, 31, v1
    v_min_u32 v4, 27, v4
    v_lshlrev_b32 v4, 7, v4
    v_lshrrev_b32 v5, 5, v1
    s_mov_b32 s59, 229376
    v_mad_u32_u24 v4, v5, s59, v4
    s_lshl_b32 s64, s58, 1
    s_add_u32 s64, s64, s76
    s_add_u32 s64, s64, 320
    s_mul_i32 s64, s64, 3584
    s_add_u32 s60, s64, 458752
    v_min_u32 v6, 39, v1
    v_lshlrev_b32 v6, 7, v6
    v_min_u32 v7, 31, v1
    v_lshlrev_b32 v7, 7, v7
    s_mul_i32 s59, s3, 458752
    s_lshl_b32 s61, s58, 12
    s_add_u32 s61, s61, s59
    s_mul_i32 s62, s58, 10240
    s_add_u32 s62, s62, s59
    s_add_u32 s62, s62, 131072
    s_add_u32 s63, s62, 5120
    v_min_u32 v8, 10, v1
    v_lshlrev_b32_e64 v8, 7, v8
    s_lshl_b32 s72, s58, 2
    s_add_u32 s72, s72, s3
    s_mul_i32 s72, s72, 1408
    s_add_u32 s72, s72, 262144
    s_add_u32 s73, s60, 458752
    buffer_load_dword v0, v7, s[44:47], s61 offen
    s_add_u32 s66, s65, 640
    s_add_u32 m0, s67, 40960
    s_nop 0
    buffer_load_dwordx4 v12, s[32:35], s66 offen offset:0 lds
    buffer_load_dwordx4 v13, s[32:35], s66 offen offset:1024 lds
    s_add_u32 s66, s65, 768
    s_add_u32 m0, s67, 49152
    s_nop 0
    buffer_load_dwordx4 v12, s[32:35], s66 offen offset:0 lds
    buffer_load_dwordx4 v13, s[32:35], s66 offen offset:1024 lds
    s_mul_i32 s58, s76, 31680
    s_add_u32 s58, s58, 98304
    s_mul_i32 s59, s77, 14784
    s_add_u32 s59, s59, s58
    v_lshl_add_u32 v224, v1, 3, s59
    v_add_u32 v225, 2112, v224
    v_add_u32 v226, 4224, v224
    v_add_u32 v227, 6336, v224
    v_add_u32 v228, 8448, v224
    v_add_u32 v229, 10560, v224
    v_add_u32 v230, 12672, v224
    v_add_u32 v231, 14784, v224
    v_and_b32_e64 v22, 31, v1
    v_lshrrev_b32 v23, 5, v1
    v_lshlrev_b32 v23, 4, v23
    s_lshl_b32 s59, s77, 8
    s_add_u32 s58, s58, s59
    v_add_u32 v23, s58, v23
    s_movk_i32 s59, 528
    v_mad_u32_u24 v113, v22, s59, v23
    v_writelane_b32 v22, 4, 5
    v_writelane_b32 v22, 4, 37
    v_writelane_b32 v22, 7, 12
    v_writelane_b32 v22, 7, 44
    v_writelane_b32 v22, 7, 13
    v_writelane_b32 v22, 7, 45
    v_writelane_b32 v22, 15, 20
    v_writelane_b32 v22, 15, 52
    v_writelane_b32 v22, 5, 28
    v_writelane_b32 v22, 5, 60
    v_writelane_b32 v22, 12, 29
    v_writelane_b32 v22, 12, 61
    v_writelane_b32 v22, 13, 30
    v_writelane_b32 v22, 13, 62
    v_writelane_b32 v22, 20, 31
    v_writelane_b32 v22, 20, 63
    v_mad_u32_u24 v112, v22, s59, v23
    v_and_b32 v16, 15, v1
    v_lshrrev_b32 v17, 4, v1
    v_lshrrev_b32 v26, 1, v16
    v_xor_b32 v26, v26, v17
    v_lshlrev_b32 v26, 4, v26
    v_lshl_add_u32 v26, v16, 7, v26
    v_add_u32 v26, s67, v26
    v_xor_b32 v27, 64, v26
    v_lshlrev_b32 v28, 4, v17
    v_add_u32 v28, 95488, v28
    v_bfe_u32 v29, v1, 2, 2
    v_lshl_add_u32 v30, v17, 3, v29
    v_lshlrev_b32 v31, 7, v30
    v_lshrrev_b32 v30, 1, v30
    v_and_b32 v30, 7, v30
    v_bfe_u32 v29, v1, 1, 1
    s_lshl_b32 s58, s3, 1
    v_or_b32 v29, s58, v29
    v_xor_b32 v29, v29, v30
    v_lshl_add_u32 v31, v29, 4, v31
    v_and_b32 v29, 1, v1
    v_lshl_add_u32 v31, v29, 3, v31
    v_xor_b32 v32, 32, v31
    v_and_b32 v29, 7, v1
    v_xor_b32 v18, v17, v29
    v_lshlrev_b32 v18, 4, v18
    v_lshl_add_u32 v18, v16, 7, v18
    s_lshl_b32 s58, s3, 12
    s_add_u32 s58, s58, 65536
    v_add_u32 v18, s58, v18
    v_xor_b32 v19, 64, v18
    v_lshrrev_b32 v30, 3, v1
    v_xor_b32 v20, v29, v30
    v_lshlrev_b32 v20, 4, v20
    v_lshl_add_u32 v20, v30, 7, v20
    v_add_u32 v20, s58, v20
    v_mul_u32_u24 v24, 4224, v30
    v_lshl_add_u32 v24, v29, 4, v24
    v_add_u32 v25, 33792, v24
    v_lshrrev_b32 v42, 3, v1
    v_and_b32 v43, 7, v1
    v_lshrrev_b32 v44, 4, v1
    v_lshlrev_b32 v44, 1, v44
    v_xor_b32 v43, v43, v44
    v_lshlrev_b32 v43, 4, v43
    v_lshl_add_u32 v34, v42, 10, v43
    v_add_u32 v35, 7168, v34
    v_add_u32 v36, 14336, v34
    v_add_u32 v37, 21504, v34
    v_lshrrev_b32 v42, 2, v1
    v_bfe_u32 v43, v1, 3, 2
    v_and_b32 v44, 3, v1
    v_lshlrev_b32 v42, 7, v42
    v_lshl_add_u32 v42, v43, 5, v42
    v_lshl_add_u32 v42, v44, 3, v42
    s_lshl_b32 s13, s3, 12
    v_add_u32 v38, s13, v42
    v_xor_b32 v39, 32, v38
    v_xor_b32_e64 v40, 64, v38
    v_xor_b32 v41, 96, v38
    v_add_u32 v42, 98304, v38
    v_add_u32 v43, 98304, v39
    v_add_u32 v44, 98304, v40
    v_add_u32 v45, 98304, v41
    s_mul_i32 s12, s3, 458752
    s_lshl_b32 s58, s57, 7
    s_add_u32 s4, s12, s58
    s_add_u32 s5, s4, 458752
    s_and_b32 s58, s53, 3
    s_lshl_b32 s58, s58, 2
    s_lshr_b32 s1, 0x5420, s58
    s_and_b32 s1, s1, 7
    s_lshl_b32 s58, s1, 16
    s_add_u32 s12, s4, s58
    s_cmp_eq_u32 s77, 0
    s_cbranch_scc0 L_kya
    s_waitcnt vmcnt(7)
    s_mov_b32 s68, 0x3fb8aa3b
    v_lshlrev_b32 v84, 16, v68
    v_mul_f32 v84, s68, v84
    v_exp_f32 v84, v84
    v_lshlrev_b32 v76, 16, v64
    v_and_b32 v77, 0xffff0000, v64
    v_pk_mul_f32 v[76:77], v[76:77], s[68:69] op_sel_hi:[1,0]
    v_cvt_pk_bf16_f32 v84, v84, v84
    v_exp_f32 v76, v76
    v_exp_f32 v77, v77
    v_and_b32 v84, 0xffff0000, v84
    v_cvt_pk_bf16_f32 v77, v76, v77
    v_lshlrev_b32 v78, 16, v65
    v_and_b32 v79, 0xffff0000, v65
    v_lshlrev_b32 v76, 16, v77
    v_and_b32 v77, 0xffff0000, v77
    v_pk_mul_f32 v[76:77], v[76:77], v[84:85] op_sel_hi:[1,0]
    v_pk_mul_f32 v[78:79], v[78:79], v[84:85] op_sel_hi:[1,0]
    v_pk_mul_f32 v[76:77], v[76:77], s[68:69] op_sel_hi:[1,0] neg_lo:[1,0] neg_hi:[1,0]
    s_mov_b32 s68, 0x3e22f983
    v_pk_mul_f32 v[78:79], v[78:79], s[68:69] op_sel_hi:[1,0]
    v_lshlrev_b32 v80, 16, v66
    v_and_b32 v82, 0xffff0000, v66
    v_lshlrev_b32 v81, 16, v67
    v_and_b32 v83, 0xffff0000, v67
    v_add_f32 v84, v84, v84
    v_pk_mul_f32 v[80:81], v[80:81], v[84:85] op_sel_hi:[1,0]
    v_pk_mul_f32 v[82:83], v[82:83], v[84:85] op_sel_hi:[1,0]
    v_fract_f32 v98, v78
    v_fract_f32 v99, v79
    v_exp_f32 v100, v76
    v_exp_f32 v101, v77
    v_cos_f32 v88, v98
    v_sin_f32 v89, v98
    v_cos_f32 v90, v99
    v_sin_f32 v91, v99
    v_pk_mul_f32 v[88:89], v[88:89], v[100:101] op_sel_hi:[1,0]
    v_pk_mul_f32 v[90:91], v[90:91], v[100:101] op_sel:[0,1] op_sel_hi:[1,1]
    s_mov_b32 s68, 0x43800000
    v_pk_mul_f32 v[96:97], v[76:77], s[68:69] op_sel_hi:[1,0]
    v_pk_mul_f32 v[98:99], v[78:79], s[68:69] op_sel_hi:[1,0]
    v_fract_f32 v98, v98
    s_add_u32 s66, s65, 896
    v_fract_f32 v99, v99
    v_exp_f32 v100, v96
    v_exp_f32 v101, v97
    v_cos_f32 v92, v98
    v_sin_f32 v93, v98
    s_add_u32 m0, s67, 57344
    v_cos_f32 v94, v99
    v_sin_f32 v95, v99
    v_pk_mul_f32 v[92:93], v[92:93], v[100:101] op_sel_hi:[1,0]
    v_pk_mul_f32 v[94:95], v[94:95], v[100:101] op_sel:[0,1] op_sel_hi:[1,1]
    v_cvt_pk_bf16_f32 v232, v80, -v81
    buffer_load_dwordx4 v12, s[32:35], s66 offen offset:0 lds
    v_cvt_pk_bf16_f32 v233, v82, -v83
    v_pk_mul_f32 v[104:105], v[80:81], v[88:89] op_sel_hi:[1,0]
    v_pk_mul_f32 v[106:107], v[82:83], v[90:91] op_sel_hi:[1,0]
    v_pk_fma_f32 v[120:121], v[80:81], v[88:89], v[104:105] op_sel:[1,1,0] op_sel_hi:[0,1,1] neg_lo:[0,1,0]
    v_pk_fma_f32 v[122:123], v[82:83], v[90:91], v[106:107] op_sel:[1,1,0] op_sel_hi:[0,1,1] neg_lo:[0,1,0]
    v_cvt_pk_bf16_f32 v234, v120, -v121
    buffer_load_dwordx4 v13, s[32:35], s66 offen offset:1024 lds
    v_cvt_pk_bf16_f32 v235, v122, -v123
    ds_write2_b64 v224, v[234:235], v[232:233] offset0:66 offset1:0
    v_pk_mul_f32 v[104:105], v[120:121], v[88:89] op_sel_hi:[1,0]
    v_pk_mul_f32 v[106:107], v[122:123], v[90:91] op_sel_hi:[1,0]
    v_pk_fma_f32 v[124:125], v[120:121], v[88:89], v[104:105] op_sel:[1,1,0] op_sel_hi:[0,1,1] neg_lo:[0,1,0]
    v_pk_fma_f32 v[126:127], v[122:123], v[90:91], v[106:107] op_sel:[1,1,0] op_sel_hi:[0,1,1] neg_lo:[0,1,0]
    v_cvt_pk_bf16_f32 v236, v124, -v125
    v_cvt_pk_bf16_f32 v237, v126, -v127
    v_pk_mul_f32 v[104:105], v[124:125], v[88:89] op_sel_hi:[1,0]
    v_pk_mul_f32 v[106:107], v[126:127], v[90:91] op_sel_hi:[1,0]
    buffer_load_dword v0, v4, s[36:39], s64 offen
    v_pk_fma_f32 v[128:129], v[124:125], v[88:89], v[104:105] op_sel:[1,1,0] op_sel_hi:[0,1,1] neg_lo:[0,1,0]
    v_pk_fma_f32 v[130:131], v[126:127], v[90:91], v[106:107] op_sel:[1,1,0] op_sel_hi:[0,1,1] neg_lo:[0,1,0]
    v_cvt_pk_bf16_f32 v238, v128, -v129
    v_cvt_pk_bf16_f32 v239, v130, -v131
    ds_write2_b64 v224, v[238:239], v[236:237] offset0:198 offset1:132
    v_pk_mul_f32 v[104:105], v[128:129], v[88:89] op_sel_hi:[1,0]
    buffer_load_dword v0, v4, s[36:39], s60 offen
    v_pk_mul_f32 v[106:107], v[130:131], v[90:91] op_sel_hi:[1,0]
    v_pk_fma_f32 v[132:133], v[128:129], v[88:89], v[104:105] op_sel:[1,1,0] op_sel_hi:[0,1,1] neg_lo:[0,1,0]
    v_pk_fma_f32 v[134:135], v[130:131], v[90:91], v[106:107] op_sel:[1,1,0] op_sel_hi:[0,1,1] neg_lo:[0,1,0]
    v_cvt_pk_bf16_f32 v240, v132, -v133
    v_cvt_pk_bf16_f32 v241, v134, -v135
    buffer_load_dword v0, v8, s[40:43], s72 offen
    v_pk_mul_f32 v[104:105], v[132:133], v[88:89] op_sel_hi:[1,0]
    v_pk_mul_f32 v[106:107], v[134:135], v[90:91] op_sel_hi:[1,0]
    v_pk_fma_f32 v[136:137], v[132:133], v[88:89], v[104:105] op_sel:[1,1,0] op_sel_hi:[0,1,1] neg_lo:[0,1,0]
    v_pk_fma_f32 v[138:139], v[134:135], v[90:91], v[106:107] op_sel:[1,1,0] op_sel_hi:[0,1,1] neg_lo:[0,1,0]
    v_cvt_pk_bf16_f32 v242, v136, -v137
    s_add_u32 s66, s65, 0
    v_cvt_pk_bf16_f32 v243, v138, -v139
    ds_write2_b64 v226, v[242:243], v[240:241] offset0:66 offset1:0
    v_pk_mul_f32 v[104:105], v[136:137], v[88:89] op_sel_hi:[1,0]
    v_pk_mul_f32 v[106:107], v[138:139], v[90:91] op_sel_hi:[1,0]
    v_pk_fma_f32 v[140:141], v[136:137], v[88:89], v[104:105] op_sel:[1,1,0] op_sel_hi:[0,1,1] neg_lo:[0,1,0]
    v_pk_fma_f32 v[142:143], v[138:139], v[90:91], v[106:107] op_sel:[1,1,0] op_sel_hi:[0,1,1] neg_lo:[0,1,0]
    s_add_u32 m0, s67, 0
    v_cvt_pk_bf16_f32 v244, v140, -v141
    v_cvt_pk_bf16_f32 v245, v142, -v143
    v_pk_mul_f32 v[104:105], v[140:141], v[88:89] op_sel_hi:[1,0]
    v_pk_mul_f32 v[106:107], v[142:143], v[90:91] op_sel_hi:[1,0]
    v_pk_fma_f32 v[144:145], v[140:141], v[88:89], v[104:105] op_sel:[1,1,0] op_sel_hi:[0,1,1] neg_lo:[0,1,0]
    buffer_load_dwordx4 v12, s[32:35], s66 offen offset:0 lds
    v_pk_fma_f32 v[146:147], v[142:143], v[90:91], v[106:107] op_sel:[1,1,0] op_sel_hi:[0,1,1] neg_lo:[0,1,0]
    v_cvt_pk_bf16_f32 v246, v144, -v145
    v_cvt_pk_bf16_f32 v247, v146, -v147
    ds_write2_b64 v226, v[246:247], v[244:245] offset0:198 offset1:132
    v_pk_mul_f32 v[104:105], v[144:145], v[88:89] op_sel_hi:[1,0]
    v_pk_mul_f32 v[106:107], v[146:147], v[90:91] op_sel_hi:[1,0]
    buffer_load_dwordx4 v13, s[32:35], s66 offen offset:1024 lds
    v_pk_fma_f32 v[148:149], v[144:145], v[88:89], v[104:105] op_sel:[1,1,0] op_sel_hi:[0,1,1] neg_lo:[0,1,0]
    v_pk_fma_f32 v[150:151], v[146:147], v[90:91], v[106:107] op_sel:[1,1,0] op_sel_hi:[0,1,1] neg_lo:[0,1,0]
    v_cvt_pk_bf16_f32 v248, v148, -v149
    v_cvt_pk_bf16_f32 v249, v150, -v151
    v_pk_mul_f32 v[104:105], v[80:81], v[92:93] op_sel_hi:[1,0]
    v_pk_mul_f32 v[106:107], v[82:83], v[94:95] op_sel_hi:[1,0]
    v_pk_fma_f32 v[80:81], v[80:81], v[92:93], v[104:105] op_sel:[1,1,0] op_sel_hi:[0,1,1] neg_lo:[0,1,0]
    v_pk_fma_f32 v[82:83], v[82:83], v[94:95], v[106:107] op_sel:[1,1,0] op_sel_hi:[0,1,1] neg_lo:[0,1,0]
    v_cvt_pk_bf16_f32 v250, v80, -v81
    v_cvt_pk_bf16_f32 v251, v82, -v83
    s_add_u32 s66, s65, 128
    v_pk_mul_f32 v[104:105], v[124:125], v[92:93] op_sel_hi:[1,0]
    v_pk_mul_f32 v[106:107], v[126:127], v[94:95] op_sel_hi:[1,0]
    v_pk_fma_f32 v[124:125], v[124:125], v[92:93], v[104:105] op_sel:[1,1,0] op_sel_hi:[0,1,1] neg_lo:[0,1,0]
    v_pk_fma_f32 v[126:127], v[126:127], v[94:95], v[106:107] op_sel:[1,1,0] op_sel_hi:[0,1,1] neg_lo:[0,1,0]
    v_cvt_pk_bf16_f32 v252, v124, -v125
    v_cvt_pk_bf16_f32 v253, v126, -v127
    s_add_u32 m0, s67, 8192
    v_pk_mul_f32 v[104:105], v[132:133], v[92:93] op_sel_hi:[1,0]
    v_pk_mul_f32 v[106:107], v[134:135], v[94:95] op_sel_hi:[1,0]
    v_pk_fma_f32 v[132:133], v[132:133], v[92:93], v[104:105] op_sel:[1,1,0] op_sel_hi:[0,1,1] neg_lo:[0,1,0]
    v_pk_fma_f32 v[134:135], v[134:135], v[94:95], v[106:107] op_sel:[1,1,0] op_sel_hi:[0,1,1] neg_lo:[0,1,0]
    v_cvt_pk_bf16_f32 v254, v132, -v133
    buffer_load_dwordx4 v12, s[32:35], s66 offen offset:0 lds
    v_cvt_pk_bf16_f32 v255, v134, -v135
    ds_write2_b64 v225, v[254:255], v[252:253] offset0:198 offset1:132
    v_pk_mul_f32 v[104:105], v[140:141], v[92:93] op_sel_hi:[1,0]
    v_pk_mul_f32 v[106:107], v[142:143], v[94:95] op_sel_hi:[1,0]
    v_pk_fma_f32 v[140:141], v[140:141], v[92:93], v[104:105] op_sel:[1,1,0] op_sel_hi:[0,1,1] neg_lo:[0,1,0]
    buffer_load_dwordx4 v13, s[32:35], s66 offen offset:1024 lds
    v_pk_fma_f32 v[142:143], v[142:143], v[94:95], v[106:107] op_sel:[1,1,0] op_sel_hi:[0,1,1] neg_lo:[0,1,0]
    v_cvt_pk_bf16_f32 v232, v140, -v141
    v_cvt_pk_bf16_f32 v233, v142, -v143
    v_pk_mul_f32 v[104:105], v[148:149], v[92:93] op_sel_hi:[1,0]
    v_pk_mul_f32 v[106:107], v[150:151], v[94:95] op_sel_hi:[1,0]
    v_pk_fma_f32 v[148:149], v[148:149], v[92:93], v[104:105] op_sel:[1,1,0] op_sel_hi:[0,1,1] neg_lo:[0,1,0]
    v_pk_fma_f32 v[150:151], v[150:151], v[94:95], v[106:107] op_sel:[1,1,0] op_sel_hi:[0,1,1] neg_lo:[0,1,0]
    v_cvt_pk_bf16_f32 v234, v148, -v149
    v_cvt_pk_bf16_f32 v235, v150, -v151
    ds_write2_b64 v227, v[234:235], v[232:233] offset0:198 offset1:132
    v_pk_mul_f32 v[104:105], v[80:81], v[92:93] op_sel_hi:[1,0]
    s_add_u32 s66, s65, 256
    v_pk_mul_f32 v[106:107], v[82:83], v[94:95] op_sel_hi:[1,0]
    v_pk_fma_f32 v[80:81], v[80:81], v[92:93], v[104:105] op_sel:[1,1,0] op_sel_hi:[0,1,1] neg_lo:[0,1,0]
    v_pk_fma_f32 v[82:83], v[82:83], v[94:95], v[106:107] op_sel:[1,1,0] op_sel_hi:[0,1,1] neg_lo:[0,1,0]
    v_cvt_pk_bf16_f32 v236, v80, -v81
    v_cvt_pk_bf16_f32 v237, v82, -v83
    ds_write2_b64 v228, v[236:237], v[248:249] offset0:66 offset1:0
    s_add_u32 m0, s67, 16384
    v_pk_mul_f32 v[104:105], v[132:133], v[92:93] op_sel_hi:[1,0]
    v_pk_mul_f32 v[106:107], v[134:135], v[94:95] op_sel_hi:[1,0]
    v_pk_fma_f32 v[132:133], v[132:133], v[92:93], v[104:105] op_sel:[1,1,0] op_sel_hi:[0,1,1] neg_lo:[0,1,0]
    v_pk_fma_f32 v[134:135], v[134:135], v[94:95], v[106:107] op_sel:[1,1,0] op_sel_hi:[0,1,1] neg_lo:[0,1,0]
    v_cvt_pk_bf16_f32 v238, v132, -v133
    buffer_load_dwordx4 v12, s[32:35], s66 offen offset:0 lds
    v_cvt_pk_bf16_f32 v239, v134, -v135
    v_pk_mul_f32 v[104:105], v[148:149], v[92:93] op_sel_hi:[1,0]
    v_pk_mul_f32 v[106:107], v[150:151], v[94:95] op_sel_hi:[1,0]
    v_pk_fma_f32 v[148:149], v[148:149], v[92:93], v[104:105] op_sel:[1,1,0] op_sel_hi:[0,1,1] neg_lo:[0,1,0]
    v_pk_fma_f32 v[150:151], v[150:151], v[94:95], v[106:107] op_sel:[1,1,0] op_sel_hi:[0,1,1] neg_lo:[0,1,0]
    buffer_load_dwordx4 v13, s[32:35], s66 offen offset:1024 lds
    v_cvt_pk_bf16_f32 v240, v148, -v149
    v_cvt_pk_bf16_f32 v241, v150, -v151
    ds_write2_b64 v228, v[240:241], v[238:239] offset0:198 offset1:132
    v_pk_mul_f32 v[104:105], v[80:81], v[92:93] op_sel_hi:[1,0]
    v_pk_mul_f32 v[106:107], v[82:83], v[94:95] op_sel_hi:[1,0]
    v_pk_fma_f32 v[80:81], v[80:81], v[92:93], v[104:105] op_sel:[1,1,0] op_sel_hi:[0,1,1] neg_lo:[0,1,0]
    v_pk_fma_f32 v[82:83], v[82:83], v[94:95], v[106:107] op_sel:[1,1,0] op_sel_hi:[0,1,1] neg_lo:[0,1,0]
    v_cvt_pk_bf16_f32 v242, v80, -v81
    v_cvt_pk_bf16_f32 v243, v82, -v83
    v_pk_mul_f32 v[104:105], v[132:133], v[92:93] op_sel_hi:[1,0]
    v_pk_mul_f32 v[106:107], v[134:135], v[94:95] op_sel_hi:[1,0]
    s_add_u32 s66, s65, 384
    v_pk_fma_f32 v[132:133], v[132:133], v[92:93], v[104:105] op_sel:[1,1,0] op_sel_hi:[0,1,1] neg_lo:[0,1,0]
    v_pk_fma_f32 v[134:135], v[134:135], v[94:95], v[106:107] op_sel:[1,1,0] op_sel_hi:[0,1,1] neg_lo:[0,1,0]
    v_cvt_pk_bf16_f32 v244, v132, -v133
    v_cvt_pk_bf16_f32 v245, v134, -v135
    ds_write2_b64 v229, v[244:245], v[242:243] offset0:132 offset1:66
    s_add_u32 m0, s67, 24576
    v_pk_mul_f32 v[104:105], v[148:149], v[92:93] op_sel_hi:[1,0]
    v_pk_mul_f32 v[106:107], v[150:151], v[94:95] op_sel_hi:[1,0]
    v_pk_fma_f32 v[148:149], v[148:149], v[92:93], v[104:105] op_sel:[1,1,0] op_sel_hi:[0,1,1] neg_lo:[0,1,0]
    v_pk_fma_f32 v[150:151], v[150:151], v[94:95], v[106:107] op_sel:[1,1,0] op_sel_hi:[0,1,1] neg_lo:[0,1,0]
    v_cvt_pk_bf16_f32 v246, v148, -v149
    v_cvt_pk_bf16_f32 v247, v150, -v151
    buffer_load_dwordx4 v12, s[32:35], s66 offen offset:0 lds
    v_pk_mul_f32 v[104:105], v[80:81], v[92:93] op_sel_hi:[1,0]
    v_pk_mul_f32 v[106:107], v[82:83], v[94:95] op_sel_hi:[1,0]
    v_pk_fma_f32 v[80:81], v[80:81], v[92:93], v[104:105] op_sel:[1,1,0] op_sel_hi:[0,1,1] neg_lo:[0,1,0]
    v_pk_fma_f32 v[82:83], v[82:83], v[94:95], v[106:107] op_sel:[1,1,0] op_sel_hi:[0,1,1] neg_lo:[0,1,0]
    v_cvt_pk_bf16_f32 v252, v80, -v81
    buffer_load_dwordx4 v13, s[32:35], s66 offen offset:1024 lds
    v_cvt_pk_bf16_f32 v253, v82, -v83
    v_pk_mul_f32 v[104:105], v[148:149], v[92:93] op_sel_hi:[1,0]
    v_pk_mul_f32 v[106:107], v[150:151], v[94:95] op_sel_hi:[1,0]
    v_pk_fma_f32 v[148:149], v[148:149], v[92:93], v[104:105] op_sel:[1,1,0] op_sel_hi:[0,1,1] neg_lo:[0,1,0]
    v_pk_fma_f32 v[150:151], v[150:151], v[94:95], v[106:107] op_sel:[1,1,0] op_sel_hi:[0,1,1] neg_lo:[0,1,0]
    v_cvt_pk_bf16_f32 v254, v148, -v149
    v_cvt_pk_bf16_f32 v255, v150, -v151
    ds_write2_b64 v230, v[254:255], v[252:253] offset0:66 offset1:0
    v_pk_mul_f32 v[104:105], v[80:81], v[92:93] op_sel_hi:[1,0]
    v_pk_mul_f32 v[106:107], v[82:83], v[94:95] op_sel_hi:[1,0]
    v_pk_fma_f32 v[80:81], v[80:81], v[92:93], v[104:105] op_sel:[1,1,0] op_sel_hi:[0,1,1] neg_lo:[0,1,0]
    s_add_u32 s66, s65, 512
    v_pk_fma_f32 v[82:83], v[82:83], v[94:95], v[106:107] op_sel:[1,1,0] op_sel_hi:[0,1,1] neg_lo:[0,1,0]
    v_cvt_pk_bf16_f32 v232, v80, -v81
    v_cvt_pk_bf16_f32 v233, v82, -v83
    v_pk_mul_f32 v[104:105], v[148:149], v[92:93] op_sel_hi:[1,0]
    v_pk_mul_f32 v[106:107], v[150:151], v[94:95] op_sel_hi:[1,0]
    s_add_u32 m0, s67, 32768
    v_pk_fma_f32 v[148:149], v[148:149], v[92:93], v[104:105] op_sel:[1,1,0] op_sel_hi:[0,1,1] neg_lo:[0,1,0]
    v_pk_fma_f32 v[150:151], v[150:151], v[94:95], v[106:107] op_sel:[1,1,0] op_sel_hi:[0,1,1] neg_lo:[0,1,0]
    v_cvt_pk_bf16_f32 v234, v148, -v149
    v_cvt_pk_bf16_f32 v235, v150, -v151
    ds_write2_b64 v230, v[234:235], v[232:233] offset0:198 offset1:132
    v_pk_mul_f32 v[104:105], v[80:81], v[92:93] op_sel_hi:[1,0]
    buffer_load_dwordx4 v12, s[32:35], s66 offen offset:0 lds
    v_pk_mul_f32 v[106:107], v[82:83], v[94:95] op_sel_hi:[1,0]
    v_pk_fma_f32 v[80:81], v[80:81], v[92:93], v[104:105] op_sel:[1,1,0] op_sel_hi:[0,1,1] neg_lo:[0,1,0]
    v_pk_fma_f32 v[82:83], v[82:83], v[94:95], v[106:107] op_sel:[1,1,0] op_sel_hi:[0,1,1] neg_lo:[0,1,0]
    v_cvt_pk_bf16_f32 v248, v80, -v81
    v_cvt_pk_bf16_f32 v249, v82, -v83
    buffer_load_dwordx4 v13, s[32:35], s66 offen offset:1024 lds
    ds_write2_b64 v225, v[248:249], v[250:251] offset0:66 offset1:0
    v_pk_mul_f32 v[104:105], v[148:149], v[92:93] op_sel_hi:[1,0]
    v_pk_mul_f32 v[106:107], v[150:151], v[94:95] op_sel_hi:[1,0]
    v_pk_fma_f32 v[148:149], v[148:149], v[92:93], v[104:105] op_sel:[1,1,0] op_sel_hi:[0,1,1] neg_lo:[0,1,0]
    v_pk_fma_f32 v[150:151], v[150:151], v[94:95], v[106:107] op_sel:[1,1,0] op_sel_hi:[0,1,1] neg_lo:[0,1,0]
    v_cvt_pk_bf16_f32 v236, v148, -v149
    v_cvt_pk_bf16_f32 v237, v150, -v151
    v_pk_mul_f32 v[104:105], v[80:81], v[92:93] op_sel_hi:[1,0]
    v_pk_mul_f32 v[106:107], v[82:83], v[94:95] op_sel_hi:[1,0]
    v_pk_fma_f32 v[80:81], v[80:81], v[92:93], v[104:105] op_sel:[1,1,0] op_sel_hi:[0,1,1] neg_lo:[0,1,0]
    v_pk_fma_f32 v[82:83], v[82:83], v[94:95], v[106:107] op_sel:[1,1,0] op_sel_hi:[0,1,1] neg_lo:[0,1,0]
    s_mov_b32 m0, 95488
    v_cvt_pk_bf16_f32 v238, v80, -v81
    v_cvt_pk_bf16_f32 v239, v82, -v83
    ds_write2_b64 v227, v[238:239], v[236:237] offset0:66 offset1:0
    v_pk_mul_f32 v[104:105], v[148:149], v[92:93] op_sel_hi:[1,0]
    v_pk_mul_f32 v[106:107], v[150:151], v[94:95] op_sel_hi:[1,0]
    global_load_lds_dwordx4 v2, s[26:27]
    v_pk_fma_f32 v[148:149], v[148:149], v[92:93], v[104:105] op_sel:[1,1,0] op_sel_hi:[0,1,1] neg_lo:[0,1,0]
    v_pk_fma_f32 v[150:151], v[150:151], v[94:95], v[106:107] op_sel:[1,1,0] op_sel_hi:[0,1,1] neg_lo:[0,1,0]
    v_cvt_pk_bf16_f32 v240, v148, -v149
    v_cvt_pk_bf16_f32 v241, v150, -v151
    ds_write2_b64 v229, v[240:241], v[246:247] offset0:0 offset1:198
    s_branch L_kja
L_kya:
    s_waitcnt vmcnt(7)
    s_mov_b32 s68, 0x3fb8aa3b
    v_lshlrev_b32_e64 v84, 16, v68
    v_mul_f32 v84, s68, v84
    v_exp_f32 v84, v84
    v_lshlrev_b32 v76, 16, v64
    v_and_b32 v77, 0xffff0000, v64
    v_pk_mul_f32 v[76:77], v[76:77], s[68:69] op_sel_hi:[1,0]
    v_cvt_pk_bf16_f32 v84, v84, v84
    v_exp_f32 v76, v76
    v_exp_f32 v77, v77
    v_and_b32 v84, 0xffff0000, v84
    v_cvt_pk_bf16_f32 v77, v76, v77
    v_lshlrev_b32 v78, 16, v65
    v_and_b32 v79, 0xffff0000, v65
    v_lshlrev_b32 v76, 16, v77
    v_and_b32 v77, 0xffff0000, v77
    v_pk_mul_f32 v[76:77], v[76:77], v[84:85] op_sel_hi:[1,0]
    v_pk_mul_f32 v[78:79], v[78:79], v[84:85] op_sel_hi:[1,0]
    v_pk_mul_f32 v[76:77], v[76:77], s[68:69] op_sel_hi:[1,0] neg_lo:[1,0] neg_hi:[1,0]
    s_mov_b32 s68, 0x3e22f983
    v_pk_mul_f32 v[78:79], v[78:79], s[68:69] op_sel_hi:[1,0]
    s_mov_b32 s68, 0x41000000
    v_pk_mul_f32 v[96:97], v[76:77], s[68:69] op_sel_hi:[1,0]
    v_pk_mul_f32 v[98:99], v[78:79], s[68:69] op_sel_hi:[1,0]
    v_fract_f32 v98, v98
    v_fract_f32 v99, v99
    v_exp_f32 v100, v96
    v_exp_f32 v101, v97
    v_cos_f32 v88, v98
    v_sin_f32 v89, v98
    v_cos_f32 v90, v99
    v_sin_f32 v91, v99
    v_pk_mul_f32 v[88:89], v[88:89], v[100:101] op_sel_hi:[1,0]
    v_pk_mul_f32 v[90:91], v[90:91], v[100:101] op_sel:[0,1] op_sel_hi:[1,1]
    v_mov_b32 v232, 0x3f80
    v_mov_b32 v233, 0x3f80
    v_cvt_pk_bf16_f32 v234, v88, v89
    v_cvt_pk_bf16_f32 v235, v90, v91
    ds_write2_b64 v231, v[234:235], v[232:233] offset0:132 offset1:198
    v_pk_mul_f32 v[104:105], v[88:89], v[88:89] op_sel_hi:[1,0]
    v_pk_mul_f32 v[106:107], v[90:91], v[90:91] op_sel_hi:[1,0]
    v_pk_fma_f32 v[92:93], v[88:89], v[88:89], v[104:105] op_sel:[1,1,0] op_sel_hi:[0,1,1] neg_lo:[0,1,0]
    v_pk_fma_f32 v[94:95], v[90:91], v[90:91], v[106:107] op_sel:[1,1,0] op_sel_hi:[0,1,1] neg_lo:[0,1,0]
    s_add_u32 s66, s65, 896
    v_cvt_pk_bf16_f32 v236, v92, v93
    v_cvt_pk_bf16_f32 v237, v94, v95
    v_pk_mul_f32 v[104:105], v[92:93], v[88:89] op_sel_hi:[1,0]
    v_pk_mul_f32 v[106:107], v[94:95], v[90:91] op_sel_hi:[1,0]
    v_pk_fma_f32 v[92:93], v[92:93], v[88:89], v[104:105] op_sel:[1,1,0] op_sel_hi:[0,1,1] neg_lo:[0,1,0]
    s_add_u32 m0, s67, 57344
    v_pk_fma_f32 v[94:95], v[94:95], v[90:91], v[106:107] op_sel:[1,1,0] op_sel_hi:[0,1,1] neg_lo:[0,1,0]
    v_cvt_pk_bf16_f32 v238, v92, v93
    v_cvt_pk_bf16_f32 v239, v94, v95
    ds_write2_b64 v231, v[238:239], v[236:237] offset0:0 offset1:66
    v_pk_mul_f32 v[104:105], v[92:93], v[88:89] op_sel_hi:[1,0]
    buffer_load_dwordx4 v12, s[32:35], s66 offen offset:0 lds
    v_pk_mul_f32 v[106:107], v[94:95], v[90:91] op_sel_hi:[1,0]
    v_pk_fma_f32 v[92:93], v[92:93], v[88:89], v[104:105] op_sel:[1,1,0] op_sel_hi:[0,1,1] neg_lo:[0,1,0]
    v_pk_fma_f32 v[94:95], v[94:95], v[90:91], v[106:107] op_sel:[1,1,0] op_sel_hi:[0,1,1] neg_lo:[0,1,0]
    v_cvt_pk_bf16_f32 v240, v92, v93
    v_cvt_pk_bf16_f32 v241, v94, v95
    v_pk_mul_f32 v[104:105], v[92:93], v[88:89] op_sel_hi:[1,0]
    buffer_load_dwordx4 v13, s[32:35], s66 offen offset:1024 lds
    v_pk_mul_f32 v[106:107], v[94:95], v[90:91] op_sel_hi:[1,0]
    v_pk_fma_f32 v[92:93], v[92:93], v[88:89], v[104:105] op_sel:[1,1,0] op_sel_hi:[0,1,1] neg_lo:[0,1,0]
    v_pk_fma_f32 v[94:95], v[94:95], v[90:91], v[106:107] op_sel:[1,1,0] op_sel_hi:[0,1,1] neg_lo:[0,1,0]
    v_cvt_pk_bf16_f32 v242, v92, v93
    v_cvt_pk_bf16_f32 v243, v94, v95
    ds_write2_b64 v230, v[242:243], v[240:241] offset0:132 offset1:198
    v_pk_mul_f32 v[104:105], v[92:93], v[88:89] op_sel_hi:[1,0]
    v_pk_mul_f32 v[106:107], v[94:95], v[90:91] op_sel_hi:[1,0]
    v_pk_fma_f32 v[92:93], v[92:93], v[88:89], v[104:105] op_sel:[1,1,0] op_sel_hi:[0,1,1] neg_lo:[0,1,0]
    v_pk_fma_f32 v[94:95], v[94:95], v[90:91], v[106:107] op_sel:[1,1,0] op_sel_hi:[0,1,1] neg_lo:[0,1,0]
    v_cvt_pk_bf16_f32 v244, v92, v93
    buffer_load_dword v0, v4, s[36:39], s64 offen
    v_cvt_pk_bf16_f32 v245, v94, v95
    v_pk_mul_f32 v[104:105], v[92:93], v[88:89] op_sel_hi:[1,0]
    v_pk_mul_f32 v[106:107], v[94:95], v[90:91] op_sel_hi:[1,0]
    v_pk_fma_f32 v[92:93], v[92:93], v[88:89], v[104:105] op_sel:[1,1,0] op_sel_hi:[0,1,1] neg_lo:[0,1,0]
    v_pk_fma_f32 v[94:95], v[94:95], v[90:91], v[106:107] op_sel:[1,1,0] op_sel_hi:[0,1,1] neg_lo:[0,1,0]
    buffer_load_dword v0, v4, s[36:39], s60 offen
    v_cvt_pk_bf16_f32 v246, v92, v93
    v_cvt_pk_bf16_f32 v247, v94, v95
    ds_write2_b64 v230, v[246:247], v[244:245] offset0:0 offset1:66
    v_pk_mul_f32 v[104:105], v[92:93], v[88:89] op_sel_hi:[1,0]
    v_pk_mul_f32 v[106:107], v[94:95], v[90:91] op_sel_hi:[1,0]
    v_pk_fma_f32 v[92:93], v[92:93], v[88:89], v[104:105] op_sel:[1,1,0] op_sel_hi:[0,1,1] neg_lo:[0,1,0]
    buffer_load_dword v0, v8, s[40:43], s72 offen
    v_pk_fma_f32 v[94:95], v[94:95], v[90:91], v[106:107] op_sel:[1,1,0] op_sel_hi:[0,1,1] neg_lo:[0,1,0]
    v_cvt_pk_bf16_f32 v248, v92, v93
    v_cvt_pk_bf16_f32 v249, v94, v95
    v_pk_mul_f32 v[104:105], v[92:93], v[88:89] op_sel_hi:[1,0]
    v_pk_mul_f32 v[106:107], v[94:95], v[90:91] op_sel_hi:[1,0]
    s_add_u32 s66, s65, 0
    v_pk_fma_f32 v[92:93], v[92:93], v[88:89], v[104:105] op_sel:[1,1,0] op_sel_hi:[0,1,1] neg_lo:[0,1,0]
    v_pk_fma_f32 v[94:95], v[94:95], v[90:91], v[106:107] op_sel:[1,1,0] op_sel_hi:[0,1,1] neg_lo:[0,1,0]
    v_cvt_pk_bf16_f32 v250, v92, v93
    v_cvt_pk_bf16_f32 v251, v94, v95
    ds_write2_b64 v229, v[250:251], v[248:249] offset0:132 offset1:198
    v_pk_mul_f32 v[104:105], v[92:93], v[88:89] op_sel_hi:[1,0]
    s_add_u32 m0, s67, 0
    v_pk_mul_f32 v[106:107], v[94:95], v[90:91] op_sel_hi:[1,0]
    v_pk_fma_f32 v[92:93], v[92:93], v[88:89], v[104:105] op_sel:[1,1,0] op_sel_hi:[0,1,1] neg_lo:[0,1,0]
    v_pk_fma_f32 v[94:95], v[94:95], v[90:91], v[106:107] op_sel:[1,1,0] op_sel_hi:[0,1,1] neg_lo:[0,1,0]
    v_cvt_pk_bf16_f32 v252, v92, v93
    v_cvt_pk_bf16_f32 v253, v94, v95
    buffer_load_dwordx4 v12, s[32:35], s66 offen offset:0 lds
    v_pk_mul_f32 v[104:105], v[92:93], v[88:89] op_sel_hi:[1,0]
    v_pk_mul_f32 v[106:107], v[94:95], v[90:91] op_sel_hi:[1,0]
    v_pk_fma_f32 v[92:93], v[92:93], v[88:89], v[104:105] op_sel:[1,1,0] op_sel_hi:[0,1,1] neg_lo:[0,1,0]
    v_pk_fma_f32 v[94:95], v[94:95], v[90:91], v[106:107] op_sel:[1,1,0] op_sel_hi:[0,1,1] neg_lo:[0,1,0]
    v_cvt_pk_bf16_f32 v254, v92, v93
    v_cvt_pk_bf16_f32 v255, v94, v95
    buffer_load_dwordx4 v13, s[32:35], s66 offen offset:1024 lds
    ds_write2_b64 v229, v[254:255], v[252:253] offset0:0 offset1:66
    v_pk_mul_f32 v[104:105], v[92:93], v[88:89] op_sel_hi:[1,0]
    v_pk_mul_f32 v[106:107], v[94:95], v[90:91] op_sel_hi:[1,0]
    v_pk_fma_f32 v[92:93], v[92:93], v[88:89], v[104:105] op_sel:[1,1,0] op_sel_hi:[0,1,1] neg_lo:[0,1,0]
    v_pk_fma_f32 v[94:95], v[94:95], v[90:91], v[106:107] op_sel:[1,1,0] op_sel_hi:[0,1,1] neg_lo:[0,1,0]
    v_cvt_pk_bf16_f32 v232, v92, v93
    v_cvt_pk_bf16_f32 v233, v94, v95
    v_pk_mul_f32 v[104:105], v[92:93], v[88:89] op_sel_hi:[1,0]
    v_pk_mul_f32 v[106:107], v[94:95], v[90:91] op_sel_hi:[1,0]
    v_pk_fma_f32 v[92:93], v[92:93], v[88:89], v[104:105] op_sel:[1,1,0] op_sel_hi:[0,1,1] neg_lo:[0,1,0]
    v_pk_fma_f32 v[94:95], v[94:95], v[90:91], v[106:107] op_sel:[1,1,0] op_sel_hi:[0,1,1] neg_lo:[0,1,0]
    s_add_u32 s66, s65, 128
    v_cvt_pk_bf16_f32 v234, v92, v93
    v_cvt_pk_bf16_f32 v235, v94, v95
    ds_write2_b64 v228, v[234:235], v[232:233] offset0:132 offset1:198
    v_pk_mul_f32 v[104:105], v[92:93], v[88:89] op_sel_hi:[1,0]
    v_pk_mul_f32 v[106:107], v[94:95], v[90:91] op_sel_hi:[1,0]
    s_add_u32 m0, s67, 8192
    v_pk_fma_f32 v[92:93], v[92:93], v[88:89], v[104:105] op_sel:[1,1,0] op_sel_hi:[0,1,1] neg_lo:[0,1,0]
    v_pk_fma_f32 v[94:95], v[94:95], v[90:91], v[106:107] op_sel:[1,1,0] op_sel_hi:[0,1,1] neg_lo:[0,1,0]
    v_cvt_pk_bf16_f32 v236, v92, v93
    v_cvt_pk_bf16_f32 v237, v94, v95
    v_pk_mul_f32 v[104:105], v[92:93], v[88:89] op_sel_hi:[1,0]
    v_pk_mul_f32 v[106:107], v[94:95], v[90:91] op_sel_hi:[1,0]
    buffer_load_dwordx4 v12, s[32:35], s66 offen offset:0 lds
    v_pk_fma_f32 v[92:93], v[92:93], v[88:89], v[104:105] op_sel:[1,1,0] op_sel_hi:[0,1,1] neg_lo:[0,1,0]
    v_pk_fma_f32 v[94:95], v[94:95], v[90:91], v[106:107] op_sel:[1,1,0] op_sel_hi:[0,1,1] neg_lo:[0,1,0]
    v_cvt_pk_bf16_f32 v238, v92, v93
    v_cvt_pk_bf16_f32 v239, v94, v95
    ds_write2_b64 v228, v[238:239], v[236:237] offset0:0 offset1:66
    buffer_load_dwordx4 v13, s[32:35], s66 offen offset:1024 lds
    v_pk_mul_f32 v[104:105], v[92:93], v[88:89] op_sel_hi:[1,0]
    v_pk_mul_f32 v[106:107], v[94:95], v[90:91] op_sel_hi:[1,0]
    v_pk_fma_f32 v[92:93], v[92:93], v[88:89], v[104:105] op_sel:[1,1,0] op_sel_hi:[0,1,1] neg_lo:[0,1,0]
    v_pk_fma_f32 v[94:95], v[94:95], v[90:91], v[106:107] op_sel:[1,1,0] op_sel_hi:[0,1,1] neg_lo:[0,1,0]
    v_cvt_pk_bf16_f32 v240, v92, v93
    v_cvt_pk_bf16_f32 v241, v94, v95
    v_pk_mul_f32 v[104:105], v[92:93], v[88:89] op_sel_hi:[1,0]
    v_pk_mul_f32 v[106:107], v[94:95], v[90:91] op_sel_hi:[1,0]
    v_pk_fma_f32 v[92:93], v[92:93], v[88:89], v[104:105] op_sel:[1,1,0] op_sel_hi:[0,1,1] neg_lo:[0,1,0]
    v_pk_fma_f32 v[94:95], v[94:95], v[90:91], v[106:107] op_sel:[1,1,0] op_sel_hi:[0,1,1] neg_lo:[0,1,0]
    v_cvt_pk_bf16_f32 v242, v92, v93
    s_add_u32 s66, s65, 256
    v_cvt_pk_bf16_f32 v243, v94, v95
    ds_write2_b64 v227, v[242:243], v[240:241] offset0:132 offset1:198
    v_pk_mul_f32 v[104:105], v[92:93], v[88:89] op_sel_hi:[1,0]
    v_pk_mul_f32 v[106:107], v[94:95], v[90:91] op_sel_hi:[1,0]
    v_pk_fma_f32 v[92:93], v[92:93], v[88:89], v[104:105] op_sel:[1,1,0] op_sel_hi:[0,1,1] neg_lo:[0,1,0]
    v_pk_fma_f32 v[94:95], v[94:95], v[90:91], v[106:107] op_sel:[1,1,0] op_sel_hi:[0,1,1] neg_lo:[0,1,0]
    s_add_u32 m0, s67, 16384
    v_cvt_pk_bf16_f32 v244, v92, v93
    v_cvt_pk_bf16_f32 v245, v94, v95
    v_pk_mul_f32 v[104:105], v[92:93], v[88:89] op_sel_hi:[1,0]
    v_pk_mul_f32 v[106:107], v[94:95], v[90:91] op_sel_hi:[1,0]
    v_pk_fma_f32 v[92:93], v[92:93], v[88:89], v[104:105] op_sel:[1,1,0] op_sel_hi:[0,1,1] neg_lo:[0,1,0]
    buffer_load_dwordx4 v12, s[32:35], s66 offen offset:0 lds
    v_pk_fma_f32 v[94:95], v[94:95], v[90:91], v[106:107] op_sel:[1,1,0] op_sel_hi:[0,1,1] neg_lo:[0,1,0]
    v_cvt_pk_bf16_f32 v246, v92, v93
    v_cvt_pk_bf16_f32 v247, v94, v95
    ds_write2_b64 v227, v[246:247], v[244:245] offset0:0 offset1:66
    v_pk_mul_f32 v[104:105], v[92:93], v[88:89] op_sel_hi:[1,0]
    v_pk_mul_f32 v[106:107], v[94:95], v[90:91] op_sel_hi:[1,0]
    buffer_load_dwordx4 v13, s[32:35], s66 offen offset:1024 lds
    v_pk_fma_f32 v[92:93], v[92:93], v[88:89], v[104:105] op_sel:[1,1,0] op_sel_hi:[0,1,1] neg_lo:[0,1,0]
    v_pk_fma_f32 v[94:95], v[94:95], v[90:91], v[106:107] op_sel:[1,1,0] op_sel_hi:[0,1,1] neg_lo:[0,1,0]
    v_cvt_pk_bf16_f32 v248, v92, v93
    v_cvt_pk_bf16_f32 v249, v94, v95
    v_pk_mul_f32 v[104:105], v[92:93], v[88:89] op_sel_hi:[1,0]
    v_pk_mul_f32 v[106:107], v[94:95], v[90:91] op_sel_hi:[1,0]
    v_pk_fma_f32 v[92:93], v[92:93], v[88:89], v[104:105] op_sel:[1,1,0] op_sel_hi:[0,1,1] neg_lo:[0,1,0]
    v_pk_fma_f32 v[94:95], v[94:95], v[90:91], v[106:107] op_sel:[1,1,0] op_sel_hi:[0,1,1] neg_lo:[0,1,0]
    v_cvt_pk_bf16_f32 v250, v92, v93
    v_cvt_pk_bf16_f32 v251, v94, v95
    ds_write2_b64 v226, v[250:251], v[248:249] offset0:132 offset1:198
    s_add_u32 s66, s65, 384
    v_pk_mul_f32 v[104:105], v[92:93], v[88:89] op_sel_hi:[1,0]
    v_pk_mul_f32 v[106:107], v[94:95], v[90:91] op_sel_hi:[1,0]
    v_pk_fma_f32 v[92:93], v[92:93], v[88:89], v[104:105] op_sel:[1,1,0] op_sel_hi:[0,1,1] neg_lo:[0,1,0]
    v_pk_fma_f32 v[94:95], v[94:95], v[90:91], v[106:107] op_sel:[1,1,0] op_sel_hi:[0,1,1] neg_lo:[0,1,0]
    v_cvt_pk_bf16_f32 v252, v92, v93
    s_add_u32 m0, s67, 24576
    v_cvt_pk_bf16_f32 v253, v94, v95
    v_pk_mul_f32 v[104:105], v[92:93], v[88:89] op_sel_hi:[1,0]
    v_pk_mul_f32 v[106:107], v[94:95], v[90:91] op_sel_hi:[1,0]
    v_pk_fma_f32 v[92:93], v[92:93], v[88:89], v[104:105] op_sel:[1,1,0] op_sel_hi:[0,1,1] neg_lo:[0,1,0]
    v_pk_fma_f32 v[94:95], v[94:95], v[90:91], v[106:107] op_sel:[1,1,0] op_sel_hi:[0,1,1] neg_lo:[0,1,0]
    v_cvt_pk_bf16_f32 v254, v92, v93
    buffer_load_dwordx4 v12, s[32:35], s66 offen offset:0 lds
    v_cvt_pk_bf16_f32 v255, v94, v95
    ds_write2_b64 v226, v[254:255], v[252:253] offset0:0 offset1:66
    v_pk_mul_f32 v[104:105], v[92:93], v[88:89] op_sel_hi:[1,0]
    v_pk_mul_f32 v[106:107], v[94:95], v[90:91] op_sel_hi:[1,0]
    v_pk_fma_f32 v[92:93], v[92:93], v[88:89], v[104:105] op_sel:[1,1,0] op_sel_hi:[0,1,1] neg_lo:[0,1,0]
    buffer_load_dwordx4 v13, s[32:35], s66 offen offset:1024 lds
    v_pk_fma_f32 v[94:95], v[94:95], v[90:91], v[106:107] op_sel:[1,1,0] op_sel_hi:[0,1,1] neg_lo:[0,1,0]
    v_cvt_pk_bf16_f32 v232, v92, v93
    v_cvt_pk_bf16_f32 v233, v94, v95
    v_pk_mul_f32 v[104:105], v[92:93], v[88:89] op_sel_hi:[1,0]
    v_pk_mul_f32 v[106:107], v[94:95], v[90:91] op_sel_hi:[1,0]
    v_pk_fma_f32 v[92:93], v[92:93], v[88:89], v[104:105] op_sel:[1,1,0] op_sel_hi:[0,1,1] neg_lo:[0,1,0]
    v_pk_fma_f32 v[94:95], v[94:95], v[90:91], v[106:107] op_sel:[1,1,0] op_sel_hi:[0,1,1] neg_lo:[0,1,0]
    v_cvt_pk_bf16_f32 v234, v92, v93
    v_cvt_pk_bf16_f32 v235, v94, v95
    ds_write2_b64 v225, v[234:235], v[232:233] offset0:132 offset1:198
    v_pk_mul_f32 v[104:105], v[92:93], v[88:89] op_sel_hi:[1,0]
    s_add_u32 s66, s65, 512
    v_pk_mul_f32 v[106:107], v[94:95], v[90:91] op_sel_hi:[1,0]
    v_pk_fma_f32 v[92:93], v[92:93], v[88:89], v[104:105] op_sel:[1,1,0] op_sel_hi:[0,1,1] neg_lo:[0,1,0]
    v_pk_fma_f32 v[94:95], v[94:95], v[90:91], v[106:107] op_sel:[1,1,0] op_sel_hi:[0,1,1] neg_lo:[0,1,0]
    v_cvt_pk_bf16_f32 v236, v92, v93
    v_cvt_pk_bf16_f32 v237, v94, v95
    v_pk_mul_f32 v[104:105], v[92:93], v[88:89] op_sel_hi:[1,0]
    s_add_u32 m0, s67, 32768
    v_pk_mul_f32 v[106:107], v[94:95], v[90:91] op_sel_hi:[1,0]
    v_pk_fma_f32 v[92:93], v[92:93], v[88:89], v[104:105] op_sel:[1,1,0] op_sel_hi:[0,1,1] neg_lo:[0,1,0]
    v_pk_fma_f32 v[94:95], v[94:95], v[90:91], v[106:107] op_sel:[1,1,0] op_sel_hi:[0,1,1] neg_lo:[0,1,0]
    v_cvt_pk_bf16_f32 v238, v92, v93
    v_cvt_pk_bf16_f32 v239, v94, v95
    buffer_load_dwordx4 v12, s[32:35], s66 offen offset:0 lds
    ds_write2_b64 v225, v[238:239], v[236:237] offset0:0 offset1:66
    v_pk_mul_f32 v[104:105], v[92:93], v[88:89] op_sel_hi:[1,0]
    v_pk_mul_f32 v[106:107], v[94:95], v[90:91] op_sel_hi:[1,0]
    v_pk_fma_f32 v[92:93], v[92:93], v[88:89], v[104:105] op_sel:[1,1,0] op_sel_hi:[0,1,1] neg_lo:[0,1,0]
    v_pk_fma_f32 v[94:95], v[94:95], v[90:91], v[106:107] op_sel:[1,1,0] op_sel_hi:[0,1,1] neg_lo:[0,1,0]
    v_cvt_pk_bf16_f32 v240, v92, v93
    buffer_load_dwordx4 v13, s[32:35], s66 offen offset:1024 lds
    v_cvt_pk_bf16_f32 v241, v94, v95
    v_pk_mul_f32 v[104:105], v[92:93], v[88:89] op_sel_hi:[1,0]
    v_pk_mul_f32 v[106:107], v[94:95], v[90:91] op_sel_hi:[1,0]
    v_pk_fma_f32 v[92:93], v[92:93], v[88:89], v[104:105] op_sel:[1,1,0] op_sel_hi:[0,1,1] neg_lo:[0,1,0]
    v_pk_fma_f32 v[94:95], v[94:95], v[90:91], v[106:107] op_sel:[1,1,0] op_sel_hi:[0,1,1] neg_lo:[0,1,0]
    v_cvt_pk_bf16_f32 v242, v92, v93
    v_cvt_pk_bf16_f32 v243, v94, v95
    ds_write2_b64 v224, v[242:243], v[240:241] offset0:132 offset1:198
    v_pk_mul_f32 v[104:105], v[92:93], v[88:89] op_sel_hi:[1,0]
    v_pk_mul_f32 v[106:107], v[94:95], v[90:91] op_sel_hi:[1,0]
    v_pk_fma_f32 v[92:93], v[92:93], v[88:89], v[104:105] op_sel:[1,1,0] op_sel_hi:[0,1,1] neg_lo:[0,1,0]
    s_mov_b32 m0, 95488
    v_pk_fma_f32 v[94:95], v[94:95], v[90:91], v[106:107] op_sel:[1,1,0] op_sel_hi:[0,1,1] neg_lo:[0,1,0]
    v_cvt_pk_bf16_f32 v244, v92, v93
    v_cvt_pk_bf16_f32 v245, v94, v95
    v_pk_mul_f32 v[104:105], v[92:93], v[88:89] op_sel_hi:[1,0]
    v_pk_mul_f32 v[106:107], v[94:95], v[90:91] op_sel_hi:[1,0]
    global_load_lds_dwordx4 v2, s[26:27]
    v_pk_fma_f32 v[92:93], v[92:93], v[88:89], v[104:105] op_sel:[1,1,0] op_sel_hi:[0,1,1] neg_lo:[0,1,0]
    v_pk_fma_f32 v[94:95], v[94:95], v[90:91], v[106:107] op_sel:[1,1,0] op_sel_hi:[0,1,1] neg_lo:[0,1,0]
    v_cvt_pk_bf16_f32 v246, v92, v93
    v_cvt_pk_bf16_f32 v247, v94, v95
    ds_write2_b64 v224, v[246:247], v[244:245] offset0:0 offset1:66
L_kja:
    s_waitcnt vmcnt(21)
    v_lshlrev_b32 v69, 16, v69
    v_readfirstlane_b32 s19, v3
    v_readfirstlane_b32 s71, v69
    s_waitcnt vmcnt(0) lgkmcnt(0)
    s_mul_i32 s19, s19, 0x0019660d
    s_add_u32 s19, s19, 0x3c6ef35f
    s_barrier
    buffer_load_dword v0, v6, s[44:47], s62 offen
    buffer_load_dword v0, v6, s[44:47], s63 offen
    s_sub_u32 s63, s2, 224
    s_mul_i32 s59, s3, 67584
    s_lshl_b32 s60, s63, 7
    s_add_u32 s59, s59, s60
    s_add_u32 s59, s59, 1048576
    ds_read_b64_tr_b16 v[128:129], v31 offset:0
    ds_read_b64_tr_b16 v[130:131], v32 offset:512
    ds_read_b64_tr_b16 v[132:133], v31 offset:4096
    ds_read_b64_tr_b16 v[134:135], v32 offset:4608
    ds_read_b64_tr_b16 v[136:137], v31 offset:8192
    ds_read_b64_tr_b16 v[138:139], v32 offset:8704
    ds_read_b64_tr_b16 v[140:141], v31 offset:12288
    ds_read_b64_tr_b16 v[142:143], v32 offset:12800
    ds_read_b64_tr_b16 v[144:145], v31 offset:16384
    ds_read_b64_tr_b16 v[146:147], v32 offset:16896
    ds_read_b64_tr_b16 v[148:149], v31 offset:20480
    ds_read_b64_tr_b16 v[150:151], v32 offset:20992
    ds_read_b64_tr_b16 v[152:153], v31 offset:24576
    ds_read_b64_tr_b16 v[154:155], v32 offset:25088
    ds_read_b64_tr_b16 v[156:157], v31 offset:28672
    ds_read_b64_tr_b16 v[158:159], v32 offset:29184
    ds_read_b64_tr_b16 v[160:161], v31 offset:32768
    ds_read_b64_tr_b16 v[162:163], v32 offset:33280
    ds_read_b64_tr_b16 v[164:165], v31 offset:36864
    ds_read_b64_tr_b16 v[166:167], v32 offset:37376
    ds_read_b64_tr_b16 v[168:169], v31 offset:40960
    ds_read_b64_tr_b16 v[170:171], v32 offset:41472
    ds_read_b64_tr_b16 v[172:173], v31 offset:45056
    ds_read_b64_tr_b16 v[174:175], v32 offset:45568
    ds_read_b64_tr_b16 v[176:177], v31 offset:49152
    ds_read_b64_tr_b16 v[178:179], v32 offset:49664
    ds_read_b64_tr_b16 v[180:181], v31 offset:53248
    ds_read_b64_tr_b16 v[182:183], v32 offset:53760
    ds_read_b64_tr_b16 v[184:185], v31 offset:57344
    ds_read_b64_tr_b16 v[186:187], v32 offset:57856
    ds_read_b64_tr_b16 v[188:189], v31 offset:61440
    ds_read_b64_tr_b16 v[190:191], v32 offset:61952
    s_waitcnt lgkmcnt(15)
    ds_write_b128 v18, v[128:131] offset:0
    ds_write_b128 v19, v[132:135] offset:0
    ds_read_b128 v[192:195], v20 offset:0
    s_nop 0
    ds_read_b128 v[196:199], v20 offset:1024
    ds_write_b128 v18, v[136:139] offset:2048
    ds_write_b128 v19, v[140:143] offset:2048
    ds_read_b128 v[200:203], v20 offset:2048
    ds_read_b128 v[204:207], v20 offset:3072
    s_waitcnt lgkmcnt(4)
    buffer_store_dwordx4 v[192:195], v24, s[40:43], s59 offen sc1
    buffer_store_dwordx4 v[196:199], v25, s[40:43], s59 offen sc1
    s_add_u32 s59, s59, 270336
    ds_write_b128 v18, v[144:147] offset:0
    ds_write_b128 v19, v[148:151] offset:0
    ds_read_b128 v[208:211], v20 offset:0
    ds_read_b128 v[212:215], v20 offset:1024
    s_waitcnt lgkmcnt(4)
    buffer_store_dwordx4 v[200:203], v24, s[40:43], s59 offen sc1
    buffer_store_dwordx4 v[204:207], v25, s[40:43], s59 offen sc1
    s_add_u32 s59, s59, 270336
    ds_write_b128 v18, v[152:155] offset:2048
    ds_write_b128 v19, v[156:159] offset:2048
    ds_read_b128 v[216:219], v20 offset:2048
    ds_read_b128 v[220:223], v20 offset:3072
    s_waitcnt lgkmcnt(4)
    buffer_store_dwordx4 v[208:211], v24, s[40:43], s59 offen sc1
    buffer_store_dwordx4 v[212:215], v25, s[40:43], s59 offen sc1
    s_add_u32 s59, s59, 270336
    ds_write_b128 v18, v[160:163] offset:0
    ds_write_b128 v19, v[164:167] offset:0
    ds_read_b128 v[224:227], v20 offset:0
    ds_read_b128 v[228:231], v20 offset:1024
    s_waitcnt lgkmcnt(4)
    buffer_store_dwordx4 v[216:219], v24, s[40:43], s59 offen sc1
    buffer_store_dwordx4 v[220:223], v25, s[40:43], s59 offen sc1
    s_add_u32 s59, s59, 270336
    ds_write_b128 v18, v[168:171] offset:2048
    ds_write_b128 v19, v[172:175] offset:2048
    ds_read_b128 v[232:235], v20 offset:2048
    ds_read_b128 v[236:239], v20 offset:3072
    s_waitcnt lgkmcnt(4)
    buffer_store_dwordx4 v[224:227], v24, s[40:43], s59 offen sc1
    buffer_store_dwordx4 v[228:231], v25, s[40:43], s59 offen sc1
    s_add_u32 s59, s59, 270336
    ds_write_b128 v18, v[176:179] offset:0
    ds_write_b128 v19, v[180:183] offset:0
    ds_read_b128 v[240:243], v20 offset:0
    ds_read_b128 v[244:247], v20 offset:1024
    s_waitcnt lgkmcnt(4)
    buffer_store_dwordx4 v[232:235], v24, s[40:43], s59 offen sc1
    buffer_store_dwordx4 v[236:239], v25, s[40:43], s59 offen sc1
    s_add_u32 s59, s59, 270336
    ds_write_b128 v18, v[184:187] offset:2048
    ds_write_b128 v19, v[188:191] offset:2048
    ds_read_b128 v[248:251], v20 offset:2048
    ds_read_b128 v[252:255], v20 offset:3072
    s_waitcnt lgkmcnt(4)
    buffer_store_dwordx4 v[240:243], v24, s[40:43], s59 offen sc1
    buffer_store_dwordx4 v[244:247], v25, s[40:43], s59 offen sc1
    s_add_u32 s59, s59, 270336
    s_waitcnt lgkmcnt(0)
    buffer_store_dwordx4 v[248:251], v24, s[40:43], s59 offen sc1
    buffer_store_dwordx4 v[252:255], v25, s[40:43], s59 offen sc1
    s_add_u32 s59, s59, 270336
    ds_read_b128 v[128:131], v26 offset:0
    ds_read_b128 v[132:135], v28 offset:0
    ds_read_b128 v[136:139], v27 offset:0
    ds_read_b128 v[140:143], v28 offset:64
    ds_read_b128 v[144:147], v26 offset:8192
    ds_read_b128 v[148:151], v28 offset:128
    ds_read_b128 v[152:155], v27 offset:8192
    ds_read_b128 v[156:159], v28 offset:192
    ds_read_b128 v[160:163], v26 offset:16384
    ds_read_b128 v[164:167], v28 offset:256
    ds_read_b128 v[168:171], v27 offset:16384
    ds_read_b128 v[172:175], v28 offset:320
    ds_read_b128 v[176:179], v26 offset:24576
    ds_read_b128 v[180:183], v28 offset:384
    ds_read_b128 v[184:187], v27 offset:24576
    ds_read_b128 v[188:191], v28 offset:448
    s_waitcnt lgkmcnt(14)
    v_mfma_f32_16x16x32_bf16 v[80:83], v[128:131], v[132:135], 0
    s_waitcnt lgkmcnt(12)
    v_mfma_f32_16x16x32_bf16 v[80:83], v[136:139], v[140:143], v[80:83]
    s_waitcnt lgkmcnt(10)
    v_mfma_f32_16x16x32_bf16 v[80:83], v[144:147], v[148:151], v[80:83]
    s_waitcnt lgkmcnt(8)
    v_mfma_f32_16x16x32_bf16 v[80:83], v[152:155], v[156:159], v[80:83]
    s_waitcnt lgkmcnt(6)
    v_mfma_f32_16x16x32_bf16 v[80:83], v[160:163], v[164:167], v[80:83]
    s_waitcnt lgkmcnt(4)
    v_mfma_f32_16x16x32_bf16 v[80:83], v[168:171], v[172:175], v[80:83]
    s_waitcnt lgkmcnt(2)
    v_mfma_f32_16x16x32_bf16 v[80:83], v[176:179], v[180:183], v[80:83]
    s_waitcnt lgkmcnt(0)
    v_mfma_f32_16x16x32_bf16 v[80:83], v[184:187], v[188:191], v[80:83]
    ds_read_b128 v[128:131], v26 offset:32768
    ds_read_b128 v[132:135], v28 offset:512
    ds_read_b128 v[136:139], v27 offset:32768
    ds_read_b128 v[140:143], v28 offset:576
    ds_read_b128 v[144:147], v26 offset:40960
    ds_read_b128 v[148:151], v28 offset:640
    ds_read_b128 v[152:155], v27 offset:40960
    ds_read_b128 v[156:159], v28 offset:704
    ds_read_b128 v[160:163], v26 offset:49152
    ds_read_b128 v[164:167], v28 offset:768
    ds_read_b128 v[168:171], v27 offset:49152
    ds_read_b128 v[172:175], v28 offset:832
    ds_read_b128 v[176:179], v26 offset:57344
    ds_read_b128 v[180:183], v28 offset:896
    ds_read_b128 v[184:187], v27 offset:57344
    ds_read_b128 v[188:191], v28 offset:960
    s_waitcnt lgkmcnt(14)
    v_mfma_f32_16x16x32_bf16 v[80:83], v[128:131], v[132:135], v[80:83]
    s_waitcnt lgkmcnt(12)
    v_mfma_f32_16x16x32_bf16 v[80:83], v[136:139], v[140:143], v[80:83]
    s_waitcnt lgkmcnt(10)
    v_mfma_f32_16x16x32_bf16 v[80:83], v[144:147], v[148:151], v[80:83]
    s_waitcnt lgkmcnt(8)
    v_mfma_f32_16x16x32_bf16 v[80:83], v[152:155], v[156:159], v[80:83]
    s_waitcnt lgkmcnt(6)
    v_mfma_f32_16x16x32_bf16 v[80:83], v[160:163], v[164:167], v[80:83]
    s_waitcnt lgkmcnt(4)
    v_mfma_f32_16x16x32_bf16 v[80:83], v[168:171], v[172:175], v[80:83]
    s_waitcnt lgkmcnt(2)
    v_mfma_f32_16x16x32_bf16 v[80:83], v[176:179], v[180:183], v[80:83]
    s_waitcnt lgkmcnt(0)
    v_mfma_f32_16x16x32_bf16 v[80:83], v[184:187], v[188:191], v[80:83]
    s_lshl_b32 s59, s63, 2
    s_add_u32 s59, s59, s3
    s_lshl_b32 s59, s59, 6
    s_add_u32 s59, s59, 32768
    s_lshl_b32 s60, s3, 5
    s_add_u32 s60, s60, s63
    s_lshl_b32 s60, s60, 7
    s_add_u32 s26, s60, 425984
    v_mul_f32 v80, 0xbfb8aa3b, v80
    v_mul_f32 v81, 0xbfb8aa3b, v81
    v_mul_f32 v82, 0xbfb8aa3b, v82
    v_mul_f32 v83, 0xbfb8aa3b, v83
    v_exp_f32 v80, v80
    v_exp_f32 v81, v81
    v_exp_f32 v82, v82
    v_exp_f32 v83, v83
    s_nop 0
    v_add_f32 v80, 1.0, v80
    v_add_f32 v81, 1.0, v81
    v_add_f32 v82, 1.0, v82
    v_add_f32 v83, 1.0, v83
    v_rcp_f32 v80, v80
    v_rcp_f32 v81, v81
    v_rcp_f32 v82, v82
    v_rcp_f32 v83, v83
    s_mov_b32 exec_lo, 0x00010001
    s_mov_b32 exec_hi, 0x00010001
    buffer_store_dwordx4 v[80:83], v1, s[40:43], s59 offen sc1
    s_mov_b64 exec, -1
    ds_read_b128 v[160:163], v112 offset:0
    ds_read_b128 v[164:167], v113 offset:14784
    ds_read_b128 v[168:171], v112 offset:32
    ds_read_b128 v[172:175], v113 offset:14816
    ds_read_b128 v[176:179], v112 offset:64
    ds_read_b128 v[180:183], v113 offset:14848
    ds_read_b128 v[184:187], v112 offset:96
    ds_read_b128 v[188:191], v113 offset:14880
    ds_read_b128 v[192:195], v112 offset:128
    ds_read_b128 v[196:199], v113 offset:14912
    ds_read_b128 v[200:203], v112 offset:160
    ds_read_b128 v[204:207], v113 offset:14944
    ds_read_b128 v[208:211], v112 offset:192
    ds_read_b128 v[212:215], v113 offset:14976
    ds_read_b128 v[216:219], v112 offset:224
    ds_read_b128 v[220:223], v113 offset:15008
    s_waitcnt lgkmcnt(0)
    s_barrier
    v_mfma_f32_32x32x16_bf16 v[48:63], v[160:163], v[164:167], 0
    s_add_u32 m0, s13, 0
    v_mfma_f32_32x32x16_bf16 v[48:63], v[168:171], v[172:175], v[48:63]
    buffer_load_dwordx4 v34, s[44:47], s12 offen offset:0 lds
    v_mfma_f32_32x32x16_bf16 v[48:63], v[176:179], v[180:183], v[48:63]
    v_mfma_f32_32x32x16_bf16 v[48:63], v[184:187], v[188:191], v[48:63]
    buffer_load_dwordx4 v35, s[44:47], s12 offen offset:1024 lds
    v_mfma_f32_32x32x16_bf16 v[48:63], v[192:195], v[196:199], v[48:63]
    v_mfma_f32_32x32x16_bf16 v[48:63], v[200:203], v[204:207], v[48:63]
    buffer_load_dwordx4 v36, s[44:47], s12 offen offset:2048 lds
    v_mfma_f32_32x32x16_bf16 v[48:63], v[208:211], v[212:215], v[48:63]
    v_mfma_f32_32x32x16_bf16 v[48:63], v[216:219], v[220:223], v[48:63]
    buffer_load_dwordx4 v37, s[44:47], s12 offen offset:3072 lds
    s_lshl_b32 s59, s54, 1
    s_add_u32 s12, s12, 32768
    s_add_u32 s58, s77, s59
    s_lshl_b32 s60, s55, 1
    s_add_u32 s59, s76, s60
    s_mul_i32 s14, s58, 28
    s_add_u32 s14, s14, s59
    s_lshl_b32 s14, s14, 13
    s_add_u32 s14, s14, 6291456
    s_add_u32 m0, s13, 16384
    s_add_u32 s15, s14, 4096
    s_lshl_b32 s16, s58, 5
    s_add_u32 s16, s16, s59
    s_lshl_b32 s16, s16, 7
    s_add_u32 s16, s16, 262144
    s_mul_i32 s58, s2, 8448
    s_mul_i32 s59, s76, 128
    s_add_u32 s58, s58, s59
    buffer_load_dwordx4 v34, s[44:47], s12 offen offset:0 lds
    s_lshl_b32 s59, s3, 11
    s_add_u32 s58, s58, s59
    s_add_u32 s20, s58, 1048576
    s_add_u32 s23, s58, 3407872
    s_lshl_b32 s60, s76, 9
    s_add_u32 s21, s59, s60
    s_and_b32 s22, s53, 3
    buffer_load_dwordx4 v35, s[44:47], s12 offen offset:1024 lds
    s_lshl_b32 s22, s22, 12
    s_add_u32 s22, s22, 425984
    s_lshr_b32 s58, s2, 5
    s_lshl_b32 s58, s58, 1
    s_add_u32 s58, s58, s77
    s_lshl_b32 s58, s58, 4
    s_bfe_u32 s59, s2, 0x40001
    s_add_u32 s58, s58, s59
    s_lshl_b32 s58, s58, 7
    s_and_b32 s59, s2, 1
    s_lshl_b32 s59, s59, 1
    s_add_u32 s59, s59, s76
    s_lshl_b32 s59, s59, 2
    s_add_u32 s24, s58, s59
    s_add_u32 s24, s24, 393216
    s_lshl_b32 s58, s3, 12
    s_add_u32 s58, s58, 147456
    v_add_u32_e64 v22, s58, v2
    v_xor_b32 v23, 4096, v22
    ds_write_b128 v22, v[48:51] offset:0
    ds_write_b128 v22, v[52:55] offset:1024
    ds_write_b128 v22, v[56:59] offset:2048
    ds_write_b128 v22, v[60:63] offset:3072
    s_sub_u32 s16, s2, 224
    s_lshl_b32 s16, s16, 5
    s_add_u32 s16, s16, s3
    s_add_u32 s16, s16, 28
    s_lshl_b32 s16, s16, 7
    s_add_u32 s16, s16, 262144
    s_waitcnt lgkmcnt(0)
    s_barrier
    ds_read_b128 v[24:27], v23 offset:0
    ds_read_b128 v[28:31], v23 offset:1024
    s_waitcnt lgkmcnt(0)
    v_add_f32 v48, v48, v24
    v_add_f32 v49, v49, v25
    v_add_f32 v50, v50, v26
    v_add_f32 v51, v51, v27
    v_add_f32 v52, v52, v28
    v_add_f32 v53, v53, v29
    v_add_f32 v54, v54, v30
    v_add_f32 v55, v55, v31
    ds_read_b128 v[24:27], v23 offset:2048
    ds_read_b128 v[28:31], v23 offset:3072
    s_waitcnt lgkmcnt(0)
    v_add_f32 v56, v56, v24
    v_add_f32 v57, v57, v25
    v_add_f32 v58, v58, v26
    v_add_f32 v59, v59, v27
    v_add_f32 v60, v60, v28
    v_add_f32 v61, v61, v29
    v_add_f32 v62, v62, v30
    v_add_f32 v63, v63, v31
    s_waitcnt vmcnt(6)
    s_atomic_swap s19, s[30:31], s26
    s_sub_u32 s6, 0, s77
    buffer_load_dwordx4 v36, s[44:47], s12 offen offset:2048 lds
    s_sub_u32 s7, 0, s77
    s_and_b32 s8, s6, 0x55555555
    s_and_b32 s9, s6, 0x55555555
    s_or_b32 s10, s6, 0x55555555
    s_or_b32 s11, s6, 0x55555555
    s_and_b32 s58, s6, 0x80000000
    s_mov_b32 s59, 0
    v_cvt_pk_bf16_f32 v32, v48, 0
    v_cndmask_b32 v32, v47, v32, s[58:59]
    v_cndmask_b32 v48, v48, v49, s[6:7]
    buffer_load_dwordx4 v37, s[44:47], s12 offen offset:3072 lds
    v_cndmask_b32 v49, v49, v50, s[6:7]
    v_cndmask_b32 v50, v50, v51, s[6:7]
    v_cndmask_b32 v51, v51, v52, s[6:7]
    v_cndmask_b32 v52, v52, v53, s[6:7]
    v_cndmask_b32 v53, v53, v54, s[6:7]
    v_cndmask_b32 v54, v54, v55, s[6:7]
    v_cndmask_b32 v55, v55, v56, s[6:7]
    v_and_b32 v22, 31, v1
    v_lshrrev_b32 v23, 5, v1
    v_xor_b32 v23, 1, v23
    s_add_u32 s12, s12, 32768
    s_cmp_eq_u32 s12, s5
    s_cselect_b32 s12, s4, s12
    v_lshlrev_b32 v22, 4, v22
    s_mul_i32 s60, s3, 5184
    s_add_u32 s60, s60, 65536
    v_add_u32 v22, s60, v22
    v_lshlrev_b32 v23, 9, v23
    s_add_u32 m0, s13, 32768
    v_add_u32 v22, v22, v23
    v_add_u32 v23, v22, v23
    s_add_u32 s60, s60, 4220
    v_sub_u32_e64 v33, s60, v46
    v_cvt_pk_bf16_f32 v24, v55, v54
    buffer_load_dwordx4 v34, s[44:47], s12 offen offset:0 lds
    v_cvt_pk_bf16_f32 v25, v53, v52
    v_cvt_pk_bf16_f32 v26, v51, v50
    v_cvt_pk_bf16_f32 v27, v49, v48
    v_cndmask_b32 v48, v57, v58, s[6:7]
    v_cndmask_b32 v49, v58, v59, s[6:7]
    buffer_load_dwordx4 v35, s[44:47], s12 offen offset:1024 lds
    v_cvt_pk_bf16_f32 v28, v59, v59
    v_cvt_pk_bf16_f32 v29, v49, v58
    v_cvt_pk_bf16_f32 v30, v58, v48
    v_cvt_pk_bf16_f32 v31, v57, v57
    v_cndmask_b32 v50, v60, v61, s[8:9]
    v_cndmask_b32 v51, v60, v61, s[10:11]
    v_cvt_pk_bf16_f32 v52, v61, v61
    v_cvt_pk_bf16_f32 v53, v61, v51
    v_cvt_pk_bf16_f32 v54, v50, v60
    v_cvt_pk_bf16_f32 v55, v60, v60
    v_cndmask_b32 v50, v62, v63, s[8:9]
    buffer_load_dwordx4 v36, s[44:47], s12 offen offset:2048 lds
    v_cndmask_b32 v51, v62, v63, s[10:11]
    v_cvt_pk_bf16_f32 v56, v63, v63
    v_cvt_pk_bf16_f32 v57, v63, v51
    v_cvt_pk_bf16_f32 v58, v50, v62
    v_cvt_pk_bf16_f32 v59, v62, v62
    s_mul_i32 s60, s76, 4608
    s_lshl_b32 s61, s77, 8
    s_add_u32 s60, s60, s61
    s_add_u32 s60, s60, 86272
    v_add_u32_e64 v48, s60, v46
    buffer_load_dwordx4 v37, s[44:47], s12 offen offset:3072 lds
    ds_write_b128 v22, v[24:27] offset:3072
    ds_write_b128 v22, v[28:31] offset:2048
    ds_write_b128 v23, v[52:55] offset:512
    ds_write_b128 v23, v[56:59] offset:0
    s_mov_b32 exec_hi, 0
    s_mov_b32 exec_lo, 0xff000000
    ds_write_b32 v33, v32
    s_mov_b64 exec, -1
    ds_write_b32 v48, v47
    v_and_b32 v60, 1, v1
    v_xor_b32 v60, 1, v60
    v_mul_u32_u24 v60, 5188, v60
    v_lshrrev_b32 v61, 4, v1
    s_add_u32 s12, s12, 32768
    v_lshl_add_u32 v60, v61, 4, v60
    v_bfe_u32 v62, v1, 1, 3
    v_lshlrev_b32 v62, 2, v62
    v_sub_u32 v60, v60, v62
    s_mul_i32 s60, s76, 10368
    s_add_u32 m0, s13, 49152
    s_lshl_b32 s61, s77, 8
    s_sub_u32 s60, s60, s61
    v_add_u32 v60, s60, v60
    v_add_u32 v4, 68892, v60
    v_add_u32 v5, 67868, v60
    buffer_load_dwordx4 v34, s[44:47], s12 offen offset:0 lds
    v_add_u32 v6, 66844, v60
    v_add_u32 v7, 65820, v60
    v_and_b32 v60, 15, v1
    v_lshlrev_b32 v60, 5, v60
    v_lshl_add_u32 v62, v61, 4, v60
    buffer_load_dwordx4 v35, s[44:47], s12 offen offset:1024 lds
    s_mul_i32 s60, s76, 4608
    s_sub_u32 s62, s60, s61
    s_add_u32 s62, s62, 86560
    v_add_u32 v8, s62, v62
    v_lshl_add_u32 v14, v61, 3, v60
    s_add_u32 s60, s21, 86784
    v_add_u32 v11, s60, v14
    s_add_u32 s62, s13, 131072
    v_add_u32 v9, s62, v2
    v_xor_b32 v10, 4096, v9
    s_mov_b32 s0, 1
    s_mov_b64 exec, 0
    s_cmp_eq_u32 s3, 0
    s_cbranch_scc1 L_pg0
    s_cmp_eq_u32 s3, 1
    s_cbranch_scc1 L_pg1
    s_cmp_eq_u32 s3, 2
    s_cbranch_scc1 L_pg2
    s_branch L_pg3
L_pgaux:
    buffer_load_dwordx4 v36, s[44:47], s12 offen offset:2048 lds
    buffer_load_dwordx4 v37, s[44:47], s12 offen offset:3072 lds
    s_add_u32 s12, s12, 32768
    s_cmp_eq_u32 s12, s5
    s_cselect_b32 s12, s4, s12
    s_add_u32 m0, s13, 98304
    s_nop 0
    buffer_load_dwordx4 v34, s[44:47], s12 offen offset:0 lds
    buffer_load_dwordx4 v35, s[44:47], s12 offen offset:1024 lds
    buffer_load_dwordx4 v36, s[44:47], s12 offen offset:2048 lds
    buffer_load_dwordx4 v37, s[44:47], s12 offen offset:3072 lds
    s_add_u32 s12, s12, 32768
    s_add_u32 m0, s13, 114688
    s_nop 0
    buffer_load_dwordx4 v34, s[44:47], s12 offen offset:0 lds
    buffer_load_dwordx4 v35, s[44:47], s12 offen offset:1024 lds
    buffer_load_dwordx4 v36, s[44:47], s12 offen offset:2048 lds
    buffer_load_dwordx4 v37, s[44:47], s12 offen offset:3072 lds
    s_add_u32 s12, s12, 32768
    s_cmp_eq_u32 s12, s5
    s_cselect_b32 s12, s4, s12
    s_add_u32 m0, s13, 131072
    s_nop 0
    buffer_load_dwordx4 v34, s[44:47], s12 offen offset:0 lds
    buffer_load_dwordx4 v35, s[44:47], s12 offen offset:1024 lds
    buffer_load_dwordx4 v36, s[44:47], s12 offen offset:2048 lds
    buffer_load_dwordx4 v37, s[44:47], s12 offen offset:3072 lds
    s_add_u32 s12, s12, 32768
    s_barrier
    s_add_u32 m0, s13, 147456
    s_nop 0
    buffer_load_dwordx4 v34, s[44:47], s12 offen offset:0 lds
    buffer_load_dwordx4 v35, s[44:47], s12 offen offset:1024 lds
    buffer_load_dwordx4 v36, s[44:47], s12 offen offset:2048 lds
    buffer_load_dwordx4 v37, s[44:47], s12 offen offset:3072 lds
    s_add_u32 s12, s12, 32768
    s_cmp_eq_u32 s12, s5
    s_cselect_b32 s12, s4, s12
    v_and_b32 v12, 31, v1
    v_lshlrev_b32_e64 v12, 7, v12
    buffer_load_dword v13, v12, s[40:43], s22 offen sc1
    s_waitcnt vmcnt(31)
    ds_read_b64_tr_b16 a[0:1], v38 offset:0
    ds_read_b64_tr_b16 a[4:5], v39 offset:0
    ds_read_b64_tr_b16 a[8:9], v40 offset:0
    ds_read_b64_tr_b16 a[12:13], v41 offset:0
    s_waitcnt vmcnt(29)
    ds_read_b64_tr_b16 a[2:3], v38 offset:2048
    ds_read_b64_tr_b16 a[6:7], v39 offset:2048
    ds_read_b64_tr_b16 a[10:11], v40 offset:2048
    ds_read_b64_tr_b16 a[14:15], v41 offset:2048
    s_waitcnt vmcnt(27)
    ds_read_b64_tr_b16 a[16:17], v38 offset:16384
    ds_read_b64_tr_b16 a[20:21], v39 offset:16384
    ds_read_b64_tr_b16 a[24:25], v40 offset:16384
    ds_read_b64_tr_b16 a[28:29], v41 offset:16384
    s_waitcnt vmcnt(25)
    ds_read_b64_tr_b16 a[18:19], v38 offset:18432
    ds_read_b64_tr_b16 a[22:23], v39 offset:18432
    ds_read_b64_tr_b16 a[26:27], v40 offset:18432
    ds_read_b64_tr_b16 a[30:31], v41 offset:18432
    s_waitcnt vmcnt(23)
    ds_read_b64_tr_b16 a[32:33], v38 offset:32768
    ds_read_b64_tr_b16 a[36:37], v39 offset:32768
    ds_read_b64_tr_b16 a[40:41], v40 offset:32768
    ds_read_b64_tr_b16 a[44:45], v41 offset:32768
    s_waitcnt vmcnt(21)
    ds_read_b64_tr_b16 a[34:35], v38 offset:34816
    ds_read_b64_tr_b16 a[38:39], v39 offset:34816
    ds_read_b64_tr_b16 a[42:43], v40 offset:34816
    ds_read_b64_tr_b16 a[46:47], v41 offset:34816
    s_waitcnt vmcnt(19)
    ds_read_b64_tr_b16 a[48:49], v38 offset:49152
    ds_read_b64_tr_b16 a[52:53], v39 offset:49152
    ds_read_b64_tr_b16 a[56:57], v40 offset:49152
    ds_read_b64_tr_b16 a[60:61], v41 offset:49152
    s_waitcnt vmcnt(17)
    ds_read_b64_tr_b16 a[50:51], v38 offset:51200
    ds_read_b64_tr_b16 a[54:55], v39 offset:51200
    ds_read_b64_tr_b16 a[58:59], v40 offset:51200
    ds_read_b64_tr_b16 a[62:63], v41 offset:51200
    s_waitcnt lgkmcnt(15)
    s_add_u32 m0, s13, 0
    s_nop 0
    buffer_load_dwordx4 v34, s[44:47], s12 offen offset:0 lds
    buffer_load_dwordx4 v35, s[44:47], s12 offen offset:1024 lds
    buffer_load_dwordx4 v36, s[44:47], s12 offen offset:2048 lds
    buffer_load_dwordx4 v37, s[44:47], s12 offen offset:3072 lds
    s_add_u32 s12, s12, 32768
    s_add_u32 m0, s13, 16384
    s_nop 0
    buffer_load_dwordx4 v34, s[44:47], s12 offen offset:0 lds
    buffer_load_dwordx4 v35, s[44:47], s12 offen offset:1024 lds
    buffer_load_dwordx4 v36, s[44:47], s12 offen offset:2048 lds
    buffer_load_dwordx4 v37, s[44:47], s12 offen offset:3072 lds
    s_add_u32 s12, s12, 32768
    s_cmp_eq_u32 s12, s5
    s_cselect_b32 s12, s4, s12
    s_waitcnt vmcnt(23)
    ds_read_b64_tr_b16 a[64:65], v42 offset:0
    ds_read_b64_tr_b16 a[68:69], v43 offset:0
    ds_read_b64_tr_b16 a[72:73], v44 offset:0
    ds_read_b64_tr_b16 a[76:77], v45 offset:0
    s_waitcnt vmcnt(21)
    ds_read_b64_tr_b16 a[66:67], v42 offset:2048
    ds_read_b64_tr_b16 a[70:71], v43 offset:2048
    ds_read_b64_tr_b16 a[74:75], v44 offset:2048
    ds_read_b64_tr_b16 a[78:79], v45 offset:2048
    s_waitcnt vmcnt(19)
    ds_read_b64_tr_b16 a[80:81], v42 offset:16384
    ds_read_b64_tr_b16 a[84:85], v43 offset:16384
    ds_read_b64_tr_b16 a[88:89], v44 offset:16384
    ds_read_b64_tr_b16 a[92:93], v45 offset:16384
    s_waitcnt vmcnt(17)
    ds_read_b64_tr_b16 a[82:83], v42 offset:18432
    ds_read_b64_tr_b16 a[86:87], v43 offset:18432
    ds_read_b64_tr_b16 a[90:91], v44 offset:18432
    ds_read_b64_tr_b16 a[94:95], v45 offset:18432
    s_waitcnt vmcnt(15)
    ds_read_b64_tr_b16 a[96:97], v42 offset:32768
    ds_read_b64_tr_b16 a[100:101], v43 offset:32768
    ds_read_b64_tr_b16 a[104:105], v44 offset:32768
    ds_read_b64_tr_b16 a[108:109], v45 offset:32768
    s_waitcnt vmcnt(13)
    ds_read_b64_tr_b16 a[98:99], v42 offset:34816
    ds_read_b64_tr_b16 a[102:103], v43 offset:34816
    ds_read_b64_tr_b16 a[106:107], v44 offset:34816
    ds_read_b64_tr_b16 a[110:111], v45 offset:34816
    s_waitcnt vmcnt(11)
    ds_read_b64_tr_b16 a[112:113], v42 offset:49152
    ds_read_b64_tr_b16 a[116:117], v43 offset:49152
    ds_read_b64_tr_b16 a[120:121], v44 offset:49152
    ds_read_b64_tr_b16 a[124:125], v45 offset:49152
    s_waitcnt vmcnt(9)
    ds_read_b64_tr_b16 a[114:115], v42 offset:51200
    ds_read_b64_tr_b16 a[118:119], v43 offset:51200
    ds_read_b64_tr_b16 a[122:123], v44 offset:51200
    ds_read_b64_tr_b16 a[126:127], v45 offset:51200
    s_waitcnt lgkmcnt(15)
    s_add_u32 m0, s13, 32768
    s_nop 0
    buffer_load_dwordx4 v34, s[44:47], s12 offen offset:0 lds
    buffer_load_dwordx4 v35, s[44:47], s12 offen offset:1024 lds
    s_waitcnt vmcnt(10)
    v_cmp_ne_u32_e64 vcc, s19, v13
    s_cbranch_vccnz L_spin_5
L_back_6:
    s_add_u32 m0, s21, 86784
    s_nop 0
    buffer_load_dwordx4 v2, s[40:43], s20 offen offset:0 sc1 lds
    buffer_load_dwordx4 v2, s[40:43], s20 offen offset:1024 sc1 lds
    s_add_u32 m0, s13, 32768
    s_nop 0
    buffer_load_dwordx4 v36, s[44:47], s12 offen offset:2048 lds
    buffer_load_dwordx4 v37, s[44:47], s12 offen offset:3072 lds
    s_add_u32 s12, s12, 32768
    s_add_u32 m0, s13, 49152
    s_nop 0
    buffer_load_dwordx4 v34, s[44:47], s12 offen offset:0 lds
    buffer_load_dwordx4 v35, s[44:47], s12 offen offset:1024 lds
    buffer_load_dwordx4 v36, s[44:47], s12 offen offset:2048 lds
    buffer_load_dwordx4 v37, s[44:47], s12 offen offset:3072 lds
    s_add_u32 s12, s12, 32768
    s_cmp_eq_u32 s12, s5
    s_cselect_b32 s12, s4, s12
    s_waitcnt lgkmcnt(0)
    s_branch L_join
L_spin_1:
    s_mov_b32 s70, 0
L_spin_1_l:
    s_sleep 2
    buffer_load_dword v13, v12, s[40:43], s22 offen sc1
    s_add_u32 s70, s70, 1
    s_waitcnt vmcnt(0)
    v_cmp_ne_u32 vcc, s19, v13
    s_cmp_gt_u32 s70, 30000
    s_cbranch_scc1 L_back_2
    s_cbranch_vccnz L_spin_1_l
    s_branch L_back_2
L_spin_5:
    s_mov_b32 s70, 0
L_spin_5_l:
    s_sleep 2
    buffer_load_dword v13, v12, s[40:43], s22 offen sc1
    s_add_u32 s70, s70, 1
    s_waitcnt vmcnt(0)
    v_cmp_ne_u32 vcc, s19, v13
    s_cmp_gt_u32 s70, 30000
    s_cbranch_scc1 L_back_6
    s_cbranch_vccnz L_spin_5_l
    s_branch L_back_6
.section .rodata,"a"
.p2align 6
.amdhsa_kernel gated_mix__ssm_conv_s4d__glu_gated_swiglu__prompt_kernel
  .amdhsa_next_free_vgpr 512
  .amdhsa_next_free_sgpr 102
  .amdhsa_accum_offset 256
  .amdhsa_group_segment_fixed_size 0
  .amdhsa_kernarg_size 120
  .amdhsa_user_sgpr_count 2
  .amdhsa_user_sgpr_kernarg_segment_ptr 1
  .amdhsa_system_sgpr_workgroup_id_x 1
  .amdhsa_float_denorm_mode_32 3
.end_amdhsa_kernel
```
